```python
import torch

def _softmax(x, axis=-1):
    return torch.softmax(x, dim=axis)
def _gelu(x):
    return torch.nn.functional.gelu(x, approximate="tanh")
def _silu(x):
    return torch.nn.functional.silu(x)
def _sigmoid(x):
    return torch.sigmoid(x)
def _layernorm(x, axis=-1, eps=1e-5):
    m = x.mean(dim=axis, keepdim=True)
    v = x.var(dim=axis, keepdim=True, unbiased=False)
    return (x - m) / torch.sqrt(v + eps)
def _scatter_add(tgt, idx, src, axis=0):
    return tgt.clone().index_add_(axis, idx, src)
def _segment_sum(src, seg, n):
    out = torch.zeros((n,) + src.shape[1:], dtype=src.dtype)
    return out.index_add_(0, seg, src)
def _pad(x, pw):
    flat = tuple(v for pair in reversed(pw) for v in pair)
    return torch.nn.functional.pad(x, flat)

kernel_name = 'concat_heads__mha_block_cached__gqa_block_cached__near_ridge'

def setup_inputs():

    _w = (lambda a: (lambda t: t.to(torch.bfloat16) if t.is_floating_point() else t)(torch.as_tensor(a)))
    def _A_setup():
        B, Sq, D = 16, 48, 640
        H, Sk, Dh = 32, 48, 128
        return {
            "x": _w((lambda *s: torch.randn(*s, dtype=torch.bfloat16) * 0.8)(B, Sq, D)),
            "k_cache": _w((lambda *s: torch.randn(*s, dtype=torch.bfloat16) * 0.8)(B, H, Sk, Dh)),
            "v_cache": _w((lambda *s: torch.randn(*s, dtype=torch.bfloat16) * 0.05)(B, H, Sk, Dh)),
            "wq": _w((lambda *s: torch.randn(*s, dtype=torch.bfloat16) * 0.8)(D, H * Dh) * (D ** -0.5)),
            "wo": _w((lambda *s: torch.randn(*s, dtype=torch.bfloat16) * 0.05)(H * Dh, D) * ((H * Dh) ** -0.5)),
        }
    _A_in = _A_setup()

    def _B_setup():
        B, Sq, D = 16, 48, 640
        Hq, Hkv, Sk, Dh = 32, 32, 48, 128
        assert Hq % Hkv == 0, (Hq, Hkv)
        return {
            "x": _w((lambda *s: torch.randn(*s, dtype=torch.bfloat16) * 0.8)(B, Sq, D)),
            "k_cache": _w((lambda *s: torch.randn(*s, dtype=torch.bfloat16) * 0.8)(B, Hkv, Sk, Dh)),
            "v_cache": _w((lambda *s: torch.randn(*s, dtype=torch.bfloat16) * 0.05)(B, Hkv, Sk, Dh)),
            "wq": _w((lambda *s: torch.randn(*s, dtype=torch.bfloat16) * 0.8)(D, Hq * Dh) * (D ** -0.5)),
            "wo": _w((lambda *s: torch.randn(*s, dtype=torch.bfloat16) * 0.05)(Hq * Dh, D) * ((Hq * Dh) ** -0.5)),
        }
    _B_in = _B_setup()

    return {
        "A_x": _A_in["x"],
        "A_k_cache": _A_in["k_cache"],
        "A_v_cache": _A_in["v_cache"],
        "A_wq": _A_in["wq"],
        "A_wo": _A_in["wo"],
        "B_x": _B_in["x"],
        "B_k_cache": _B_in["k_cache"],
        "B_v_cache": _B_in["v_cache"],
        "B_wq": _B_in["wq"],
        "B_wo": _B_in["wo"],
    }

def reference(A_x, A_k_cache, A_v_cache, A_wq, A_wo, B_x, B_k_cache, B_v_cache, B_wq, B_wo):
    def _A_ref(x, k_cache, v_cache, wq, wo):
        B, Sq, D = x.shape
        H, Dh = 32, 128
        q = (lambda x, *d: x.permute(*d))((x @ wq).reshape(B, Sq, H, Dh), 0, 2, 1, 3)
        scores = torch.einsum("bhqd,bhkd->bhqk", q, k_cache) * (Dh ** -0.5)
        p = _softmax(scores, axis=-1)
        o = torch.einsum("bhqk,bhkd->bhqd", p, v_cache)
        return (lambda x, *d: x.permute(*d))(o, 0, 2, 1, 3).reshape(B, Sq, H * Dh) @ wo

    def _B_ref(x, k_cache, v_cache, wq, wo):
        B, Sq, D = x.shape
        Hq, Dh = 32, 128
        Hkv = k_cache.shape[1]
        rep = Hq // Hkv
        q = (lambda x, *d: x.permute(*d))((x @ wq).reshape(B, Sq, Hq, Dh), 0, 2, 1, 3)
        k = (lambda x, n, axis: torch.repeat_interleave(x, n, dim=axis))(k_cache, rep, axis=1)
        v = (lambda x, n, axis: torch.repeat_interleave(x, n, dim=axis))(v_cache, rep, axis=1)
        scores = torch.einsum("bhqd,bhkd->bhqk", q, k) * (Dh ** -0.5)
        p = _softmax(scores, axis=-1)
        o = torch.einsum("bhqk,bhkd->bhqd", p, v)
        return (lambda x, *d: x.permute(*d))(o, 0, 2, 1, 3).reshape(B, Sq, Hq * Dh) @ wo

    a = _A_ref(A_x, A_k_cache, A_v_cache, A_wq, A_wo)
    b = _B_ref(B_x, B_k_cache, B_v_cache, B_wq, B_wo)
    return torch.concatenate([a, b], axis=-1)
```

```asm
; @launch grid=(256,1,1) block=(512,1,1) lds=163840
.amdgcn_target "amdgcn-amd-amdhsa--gfx950"
.text
.globl concat_heads__mha_block_cached__gqa_block_cached__near_ridge_kernel
.p2align 8
.type concat_heads__mha_block_cached__gqa_block_cached__near_ridge_kernel,@function
concat_heads__mha_block_cached__gqa_block_cached__near_ridge_kernel:
    s_cmp_ge_u32 s2, 256
    s_cbranch_scc1 L_done
    s_and_b32 s3, s2, 7
    s_lshr_b32 s4, s2, 3
    s_lshr_b32 s5, s3, 2
    s_mul_i32 s6, s5, 40
    s_load_dwordx4 s[28:31], s[0:1], s6
    s_load_dwordx4 s[32:35], s[0:1], s6 offset:16
    s_load_dwordx2 s[56:57], s[0:1], s6 offset:32
    s_load_dwordx4 s[92:95], s[0:1], 80
    s_load_dwordx2 s[36:37], s[0:1], 96
    v_lshrrev_b32 v112, 6, v0
    s_and_b32 s7, s3, 3
    s_lshl_b32 s7, s7, 3
    v_readfirstlane_b32 s55, v112
    s_lshr_b32 s39, s4, 2
    s_add_u32 s7, s7, s39
    s_and_b32 s38, s55, 3
    s_and_b32 s39, s4, 3
    s_lshl_b32 s39, s39, 2
    v_and_b32 v0, 63, v0
    v_and_b32 v108, 15, v0
    v_lshrrev_b32 v109, 4, v0
    v_lshlrev_b32 v107, 4, v0
    v_bfe_u32 v110, v0, 2, 2
    v_and_b32 v111, 3, v0
    s_waitcnt lgkmcnt(0)
    s_mul_i32 s40, s39, 61440
    s_add_u32 s8, s28, s40
    s_addc_u32 s9, s29, 0
    s_mov_b32 s10, 245760
    s_mov_b32 s11, 0x00020000
    s_lshl_b32 s40, s7, 8
    s_add_u32 s12, s34, s40
    s_addc_u32 s13, s35, 0
    s_sub_u32 s14, 5242880, s40
    s_mov_b32 s15, 0x00020000
    s_cmp_lt_u32 s55, 4
    s_cbranch_scc1 L_srd_rest
    s_cmp_lt_u32 s55, 6
    s_cbranch_scc1 L_wx
L_srd_rest:
    s_lshl_b32 s40, s39, 5
    s_add_u32 s40, s40, s7
    s_mul_i32 s40, s40, 12288
    s_add_u32 s16, s30, s40
    s_addc_u32 s17, s31, 0
    s_mov_b32 s18, 1191936
    s_mov_b32 s19, 0x00020000
    s_add_u32 s20, s32, s40
    s_addc_u32 s21, s33, 0
    s_mov_b32 s22, 1191936
    s_mov_b32 s23, 0x00020000
    s_mov_b32 s84, s94
    s_mov_b32 s85, s95
    s_mov_b32 s86, 256
    s_mov_b32 s87, 0x00020000
    s_cmp_lt_u32 s55, 4
    s_cbranch_scc1 L_compute
    s_branch L_kv
L_wx:
    s_lshl_b32 s42, s38, 12
    s_mul_i32 s43, s38, 12288
    v_and_b32 v112, 7, v0
    v_xor_b32 v112, v112, v109
    v_lshlrev_b32 v112, 4, v112
    v_lshrrev_b32 v113, 3, v0
    v_mul_u32_u24 v113, 1280, v113
    v_add_u32 v1, v112, v113
    s_mul_i32 s40, s38, 122880
    v_add_u32 v1, s40, v1
    v_xor_b32 v2, 64, v1
    v_lshrrev_b32 v112, 1, v109
    v_lshlrev_b32 v112, 2, v112
    v_and_b32 v113, 1, v109
    v_or_b32 v112, v112, v113
    v_xor_b32 v112, v112, v108
    v_lshlrev_b32 v112, 4, v112
    v_lshlrev_b32 v113, 13, v109
    v_add_u32 v3, v112, v113
    s_lshl_b32 s40, s38, 17
    v_add_u32 v3, s40, v3
    v_xor_b32 v4, 128, v3
    s_and_b32 s50, s4, 3
    s_mul_i32 s50, s50, 3
    s_lshr_b32 s51, s4, 2
    s_mul_i32 s51, s51, 1
    s_add_u32 s50, s50, s51
    s_mul_i32 s51, s50, 205
    s_lshr_b32 s51, s51, 11
    s_mul_i32 s51, s51, 10
    s_sub_u32 s50, s50, s51
    s_add_u32 s50, s50, 0
    s_lshl_b32 s51, s50, 19
    s_lshl_b32 s52, s50, 7
    s_add_u32 m0, s42, 122880
    s_add_u32 s49, s51, 0
    buffer_load_dwordx4 v3, s[12:15], s49 offen lds
    s_add_u32 m0, s42, 123904
    s_add_u32 s49, s51, 32768
    buffer_load_dwordx4 v3, s[12:15], s49 offen lds
    s_add_u32 m0, s42, 124928
    s_add_u32 s49, s51, 65536
    buffer_load_dwordx4 v4, s[12:15], s49 offen lds
    s_add_u32 m0, s42, 125952
    s_add_u32 s49, s51, 98304
    buffer_load_dwordx4 v4, s[12:15], s49 offen lds
    s_add_u32 s51, s51, 262144
    s_cmp_ge_u32 s51, 5242880
    s_cselect_b32 s51, 0, s51
    s_add_u32 m0, s43, 49152
    s_add_u32 s49, s52, 0
    buffer_load_dwordx4 v1, s[8:11], s49 offen lds
    s_add_u32 m0, s43, 50176
    s_add_u32 s49, s52, 10240
    buffer_load_dwordx4 v2, s[8:11], s49 offen lds
    s_add_u32 m0, s43, 51200
    s_add_u32 s49, s52, 20480
    buffer_load_dwordx4 v1, s[8:11], s49 offen lds
    s_add_u32 m0, s43, 52224
    s_add_u32 s49, s52, 30720
    buffer_load_dwordx4 v2, s[8:11], s49 offen lds
    s_add_u32 m0, s43, 53248
    s_add_u32 s49, s52, 40960
    buffer_load_dwordx4 v1, s[8:11], s49 offen lds
    s_add_u32 m0, s43, 54272
    s_add_u32 s49, s52, 51200
    buffer_load_dwordx4 v2, s[8:11], s49 offen lds
    s_add_u32 m0, s43, 55296
    s_add_u32 s49, s52, 61440
    buffer_load_dwordx4 v1, s[8:11], s49 offen lds
    s_add_u32 m0, s43, 56320
    s_add_u32 s49, s52, 71680
    buffer_load_dwordx4 v2, s[8:11], s49 offen lds
    s_add_u32 m0, s43, 57344
    s_add_u32 s49, s52, 81920
    buffer_load_dwordx4 v1, s[8:11], s49 offen lds
    s_add_u32 m0, s43, 58368
    s_add_u32 s49, s52, 92160
    buffer_load_dwordx4 v2, s[8:11], s49 offen lds
    s_add_u32 m0, s43, 59392
    s_add_u32 s49, s52, 102400
    buffer_load_dwordx4 v1, s[8:11], s49 offen lds
    s_add_u32 m0, s43, 60416
    s_add_u32 s49, s52, 112640
    buffer_load_dwordx4 v2, s[8:11], s49 offen lds
    s_add_u32 s52, s52, 128
    s_cmp_ge_u32 s52, 1280
    s_cselect_b32 s52, 0, s52
    s_add_u32 m0, s42, 131072
    s_add_u32 s49, s51, 0
    buffer_load_dwordx4 v3, s[12:15], s49 offen lds
    s_add_u32 m0, s42, 132096
    s_add_u32 s49, s51, 32768
    buffer_load_dwordx4 v3, s[12:15], s49 offen lds
    s_add_u32 m0, s42, 133120
    s_add_u32 s49, s51, 65536
    buffer_load_dwordx4 v4, s[12:15], s49 offen lds
    s_add_u32 m0, s42, 134144
    s_add_u32 s49, s51, 98304
    buffer_load_dwordx4 v4, s[12:15], s49 offen lds
    s_add_u32 s51, s51, 262144
    s_cmp_ge_u32 s51, 5242880
    s_cselect_b32 s51, 0, s51
    s_add_u32 m0, s43, 73728
    s_add_u32 s49, s52, 0
    buffer_load_dwordx4 v1, s[8:11], s49 offen lds
    s_add_u32 m0, s43, 74752
    s_add_u32 s49, s52, 10240
    buffer_load_dwordx4 v2, s[8:11], s49 offen lds
    s_add_u32 m0, s43, 75776
    s_add_u32 s49, s52, 20480
    buffer_load_dwordx4 v1, s[8:11], s49 offen lds
    s_add_u32 m0, s43, 76800
    s_add_u32 s49, s52, 30720
    buffer_load_dwordx4 v2, s[8:11], s49 offen lds
    s_add_u32 m0, s43, 77824
    s_add_u32 s49, s52, 40960
    buffer_load_dwordx4 v1, s[8:11], s49 offen lds
    s_add_u32 m0, s43, 78848
    s_add_u32 s49, s52, 51200
    buffer_load_dwordx4 v2, s[8:11], s49 offen lds
    s_add_u32 m0, s43, 79872
    s_add_u32 s49, s52, 61440
    buffer_load_dwordx4 v1, s[8:11], s49 offen lds
    s_add_u32 m0, s43, 80896
    s_add_u32 s49, s52, 71680
    buffer_load_dwordx4 v2, s[8:11], s49 offen lds
    s_add_u32 m0, s43, 81920
    s_add_u32 s49, s52, 81920
    buffer_load_dwordx4 v1, s[8:11], s49 offen lds
    s_add_u32 m0, s43, 82944
    s_add_u32 s49, s52, 92160
    buffer_load_dwordx4 v2, s[8:11], s49 offen lds
    s_add_u32 m0, s43, 83968
    s_add_u32 s49, s52, 102400
    buffer_load_dwordx4 v1, s[8:11], s49 offen lds
    s_add_u32 m0, s43, 84992
    s_add_u32 s49, s52, 112640
    buffer_load_dwordx4 v2, s[8:11], s49 offen lds
    s_add_u32 s52, s52, 128
    s_cmp_ge_u32 s52, 1280
    s_cselect_b32 s52, 0, s52
    s_add_u32 m0, s42, 139264
    s_add_u32 s49, s51, 0
    buffer_load_dwordx4 v3, s[12:15], s49 offen lds
    s_add_u32 m0, s42, 140288
    s_add_u32 s49, s51, 32768
    buffer_load_dwordx4 v3, s[12:15], s49 offen lds
    s_add_u32 m0, s42, 141312
    s_add_u32 s49, s51, 65536
    buffer_load_dwordx4 v4, s[12:15], s49 offen lds
    s_add_u32 m0, s42, 142336
    s_add_u32 s49, s51, 98304
    buffer_load_dwordx4 v4, s[12:15], s49 offen lds
    s_add_u32 s51, s51, 262144
    s_cmp_ge_u32 s51, 5242880
    s_cselect_b32 s51, 0, s51
    s_add_u32 m0, s42, 147456
    s_add_u32 s49, s51, 0
    buffer_load_dwordx4 v3, s[12:15], s49 offen lds
    s_add_u32 m0, s42, 148480
    s_add_u32 s49, s51, 32768
    buffer_load_dwordx4 v3, s[12:15], s49 offen lds
    s_add_u32 m0, s42, 149504
    s_add_u32 s49, s51, 65536
    buffer_load_dwordx4 v4, s[12:15], s49 offen lds
    s_add_u32 m0, s42, 150528
    s_add_u32 s49, s51, 98304
    buffer_load_dwordx4 v4, s[12:15], s49 offen lds
    s_add_u32 s51, s51, 262144
    s_cmp_ge_u32 s51, 5242880
    s_cselect_b32 s51, 0, s51
    s_waitcnt vmcnt(24)
    s_barrier
    s_add_u32 m0, s42, 155648
    s_add_u32 s49, s51, 0
    buffer_load_dwordx4 v3, s[12:15], s49 offen lds
    s_add_u32 m0, s42, 156672
    s_add_u32 s49, s51, 32768
    buffer_load_dwordx4 v3, s[12:15], s49 offen lds
    s_add_u32 m0, s42, 157696
    s_add_u32 s49, s51, 65536
    buffer_load_dwordx4 v4, s[12:15], s49 offen lds
    s_add_u32 m0, s42, 158720
    s_add_u32 s49, s51, 98304
    buffer_load_dwordx4 v4, s[12:15], s49 offen lds
    s_add_u32 s51, s51, 262144
    s_cmp_ge_u32 s51, 5242880
    s_cselect_b32 s51, 0, s51
    s_add_u32 m0, s43, 98304
    s_add_u32 s49, s52, 0
    buffer_load_dwordx4 v1, s[8:11], s49 offen lds
    s_add_u32 m0, s43, 99328
    s_add_u32 s49, s52, 10240
    buffer_load_dwordx4 v2, s[8:11], s49 offen lds
    s_add_u32 m0, s43, 100352
    s_add_u32 s49, s52, 20480
    buffer_load_dwordx4 v1, s[8:11], s49 offen lds
    s_add_u32 m0, s43, 101376
    s_add_u32 s49, s52, 30720
    buffer_load_dwordx4 v2, s[8:11], s49 offen lds
    s_add_u32 m0, s43, 102400
    s_add_u32 s49, s52, 40960
    buffer_load_dwordx4 v1, s[8:11], s49 offen lds
    s_add_u32 m0, s43, 103424
    s_add_u32 s49, s52, 51200
    buffer_load_dwordx4 v2, s[8:11], s49 offen lds
    s_waitcnt vmcnt(30)
    s_barrier
    s_add_u32 m0, s42, 122880
    s_add_u32 s49, s51, 0
    buffer_load_dwordx4 v3, s[12:15], s49 offen lds
    s_add_u32 m0, s42, 123904
    s_add_u32 s49, s51, 32768
    buffer_load_dwordx4 v3, s[12:15], s49 offen lds
    s_add_u32 m0, s42, 124928
    s_add_u32 s49, s51, 65536
    buffer_load_dwordx4 v4, s[12:15], s49 offen lds
    s_add_u32 m0, s42, 125952
    s_add_u32 s49, s51, 98304
    buffer_load_dwordx4 v4, s[12:15], s49 offen lds
    s_add_u32 s51, s51, 262144
    s_cmp_ge_u32 s51, 5242880
    s_cselect_b32 s51, 0, s51
    s_add_u32 m0, s43, 104448
    s_add_u32 s49, s52, 61440
    buffer_load_dwordx4 v1, s[8:11], s49 offen lds
    s_add_u32 m0, s43, 105472
    s_add_u32 s49, s52, 71680
    buffer_load_dwordx4 v2, s[8:11], s49 offen lds
    s_add_u32 m0, s43, 106496
    s_add_u32 s49, s52, 81920
    buffer_load_dwordx4 v1, s[8:11], s49 offen lds
    s_add_u32 m0, s43, 107520
    s_add_u32 s49, s52, 92160
    buffer_load_dwordx4 v2, s[8:11], s49 offen lds
    s_add_u32 m0, s43, 108544
    s_add_u32 s49, s52, 102400
    buffer_load_dwordx4 v1, s[8:11], s49 offen lds
    s_add_u32 m0, s43, 109568
    s_add_u32 s49, s52, 112640
    buffer_load_dwordx4 v2, s[8:11], s49 offen lds
    s_add_u32 s52, s52, 128
    s_cmp_ge_u32 s52, 1280
    s_cselect_b32 s52, 0, s52
    s_waitcnt vmcnt(24)
    s_barrier
    s_add_u32 m0, s42, 131072
    s_add_u32 s49, s51, 0
    buffer_load_dwordx4 v3, s[12:15], s49 offen lds
    s_add_u32 m0, s42, 132096
    s_add_u32 s49, s51, 32768
    buffer_load_dwordx4 v3, s[12:15], s49 offen lds
    s_add_u32 m0, s42, 133120
    s_add_u32 s49, s51, 65536
    buffer_load_dwordx4 v4, s[12:15], s49 offen lds
    s_add_u32 m0, s42, 134144
    s_add_u32 s49, s51, 98304
    buffer_load_dwordx4 v4, s[12:15], s49 offen lds
    s_add_u32 s51, s51, 262144
    s_cmp_ge_u32 s51, 5242880
    s_cselect_b32 s51, 0, s51
    s_add_u32 m0, s43, 49152
    s_add_u32 s49, s52, 0
    buffer_load_dwordx4 v1, s[8:11], s49 offen lds
    s_add_u32 m0, s43, 50176
    s_add_u32 s49, s52, 10240
    buffer_load_dwordx4 v2, s[8:11], s49 offen lds
    s_add_u32 m0, s43, 51200
    s_add_u32 s49, s52, 20480
    buffer_load_dwordx4 v1, s[8:11], s49 offen lds
    s_add_u32 m0, s43, 52224
    s_add_u32 s49, s52, 30720
    buffer_load_dwordx4 v2, s[8:11], s49 offen lds
    s_add_u32 m0, s43, 53248
    s_add_u32 s49, s52, 40960
    buffer_load_dwordx4 v1, s[8:11], s49 offen lds
    s_add_u32 m0, s43, 54272
    s_add_u32 s49, s52, 51200
    buffer_load_dwordx4 v2, s[8:11], s49 offen lds
    s_waitcnt vmcnt(30)
    s_barrier
    s_add_u32 m0, s42, 139264
    s_add_u32 s49, s51, 0
    buffer_load_dwordx4 v3, s[12:15], s49 offen lds
    s_add_u32 m0, s42, 140288
    s_add_u32 s49, s51, 32768
    buffer_load_dwordx4 v3, s[12:15], s49 offen lds
    s_add_u32 m0, s42, 141312
    s_add_u32 s49, s51, 65536
    buffer_load_dwordx4 v4, s[12:15], s49 offen lds
    s_add_u32 m0, s42, 142336
    s_add_u32 s49, s51, 98304
    buffer_load_dwordx4 v4, s[12:15], s49 offen lds
    s_add_u32 s51, s51, 262144
    s_cmp_ge_u32 s51, 5242880
    s_cselect_b32 s51, 0, s51
    s_add_u32 m0, s43, 55296
    s_add_u32 s49, s52, 61440
    buffer_load_dwordx4 v1, s[8:11], s49 offen lds
    s_add_u32 m0, s43, 56320
    s_add_u32 s49, s52, 71680
    buffer_load_dwordx4 v2, s[8:11], s49 offen lds
    s_add_u32 m0, s43, 57344
    s_add_u32 s49, s52, 81920
    buffer_load_dwordx4 v1, s[8:11], s49 offen lds
    s_add_u32 m0, s43, 58368
    s_add_u32 s49, s52, 92160
    buffer_load_dwordx4 v2, s[8:11], s49 offen lds
    s_add_u32 m0, s43, 59392
    s_add_u32 s49, s52, 102400
    buffer_load_dwordx4 v1, s[8:11], s49 offen lds
    s_add_u32 m0, s43, 60416
    s_add_u32 s49, s52, 112640
    buffer_load_dwordx4 v2, s[8:11], s49 offen lds
    s_add_u32 s52, s52, 128
    s_cmp_ge_u32 s52, 1280
    s_cselect_b32 s52, 0, s52
    s_waitcnt vmcnt(20)
    s_barrier
    s_add_u32 m0, s42, 147456
    s_add_u32 s49, s51, 0
    buffer_load_dwordx4 v3, s[12:15], s49 offen lds
    s_add_u32 m0, s42, 148480
    s_add_u32 s49, s51, 32768
    buffer_load_dwordx4 v3, s[12:15], s49 offen lds
    s_add_u32 m0, s42, 149504
    s_add_u32 s49, s51, 65536
    buffer_load_dwordx4 v4, s[12:15], s49 offen lds
    s_add_u32 m0, s42, 150528
    s_add_u32 s49, s51, 98304
    buffer_load_dwordx4 v4, s[12:15], s49 offen lds
    s_add_u32 s51, s51, 262144
    s_cmp_ge_u32 s51, 5242880
    s_cselect_b32 s51, 0, s51
    s_add_u32 m0, s43, 73728
    s_add_u32 s49, s52, 0
    buffer_load_dwordx4 v1, s[8:11], s49 offen lds
    s_add_u32 m0, s43, 74752
    s_add_u32 s49, s52, 10240
    buffer_load_dwordx4 v2, s[8:11], s49 offen lds
    s_add_u32 m0, s43, 75776
    s_add_u32 s49, s52, 20480
    buffer_load_dwordx4 v1, s[8:11], s49 offen lds
    s_add_u32 m0, s43, 76800
    s_add_u32 s49, s52, 30720
    buffer_load_dwordx4 v2, s[8:11], s49 offen lds
    s_add_u32 m0, s43, 77824
    s_add_u32 s49, s52, 40960
    buffer_load_dwordx4 v1, s[8:11], s49 offen lds
    s_add_u32 m0, s43, 78848
    s_add_u32 s49, s52, 51200
    buffer_load_dwordx4 v2, s[8:11], s49 offen lds
    s_barrier
    s_add_u32 m0, s42, 155648
    s_add_u32 s49, s51, 0
    buffer_load_dwordx4 v3, s[12:15], s49 offen lds
    s_add_u32 m0, s42, 156672
    s_add_u32 s49, s51, 32768
    buffer_load_dwordx4 v3, s[12:15], s49 offen lds
    s_add_u32 m0, s42, 157696
    s_add_u32 s49, s51, 65536
    buffer_load_dwordx4 v4, s[12:15], s49 offen lds
    s_add_u32 m0, s42, 158720
    s_add_u32 s49, s51, 98304
    buffer_load_dwordx4 v4, s[12:15], s49 offen lds
    s_add_u32 s51, s51, 262144
    s_cmp_ge_u32 s51, 5242880
    s_cselect_b32 s51, 0, s51
    s_add_u32 m0, s43, 79872
    s_add_u32 s49, s52, 61440
    buffer_load_dwordx4 v1, s[8:11], s49 offen lds
    s_add_u32 m0, s43, 80896
    s_add_u32 s49, s52, 71680
    buffer_load_dwordx4 v2, s[8:11], s49 offen lds
    s_add_u32 m0, s43, 81920
    s_add_u32 s49, s52, 81920
    buffer_load_dwordx4 v1, s[8:11], s49 offen lds
    s_add_u32 m0, s43, 82944
    s_add_u32 s49, s52, 92160
    buffer_load_dwordx4 v2, s[8:11], s49 offen lds
    s_add_u32 m0, s43, 83968
    s_add_u32 s49, s52, 102400
    buffer_load_dwordx4 v1, s[8:11], s49 offen lds
    s_add_u32 m0, s43, 84992
    s_add_u32 s49, s52, 112640
    buffer_load_dwordx4 v2, s[8:11], s49 offen lds
    s_add_u32 s52, s52, 128
    s_cmp_ge_u32 s52, 1280
    s_cselect_b32 s52, 0, s52
    s_waitcnt vmcnt(20)
    s_barrier
    s_add_u32 m0, s42, 122880
    s_add_u32 s49, s51, 0
    buffer_load_dwordx4 v3, s[12:15], s49 offen lds
    s_add_u32 m0, s42, 123904
    s_add_u32 s49, s51, 32768
    buffer_load_dwordx4 v3, s[12:15], s49 offen lds
    s_add_u32 m0, s42, 124928
    s_add_u32 s49, s51, 65536
    buffer_load_dwordx4 v4, s[12:15], s49 offen lds
    s_add_u32 m0, s42, 125952
    s_add_u32 s49, s51, 98304
    buffer_load_dwordx4 v4, s[12:15], s49 offen lds
    s_add_u32 s51, s51, 262144
    s_cmp_ge_u32 s51, 5242880
    s_cselect_b32 s51, 0, s51
    s_add_u32 m0, s43, 98304
    s_add_u32 s49, s52, 0
    buffer_load_dwordx4 v1, s[8:11], s49 offen lds
    s_add_u32 m0, s43, 99328
    s_add_u32 s49, s52, 10240
    buffer_load_dwordx4 v2, s[8:11], s49 offen lds
    s_add_u32 m0, s43, 100352
    s_add_u32 s49, s52, 20480
    buffer_load_dwordx4 v1, s[8:11], s49 offen lds
    s_add_u32 m0, s43, 101376
    s_add_u32 s49, s52, 30720
    buffer_load_dwordx4 v2, s[8:11], s49 offen lds
    s_add_u32 m0, s43, 102400
    s_add_u32 s49, s52, 40960
    buffer_load_dwordx4 v1, s[8:11], s49 offen lds
    s_add_u32 m0, s43, 103424
    s_add_u32 s49, s52, 51200
    buffer_load_dwordx4 v2, s[8:11], s49 offen lds
    s_barrier
    s_add_u32 m0, s42, 131072
    s_add_u32 s49, s51, 0
    buffer_load_dwordx4 v3, s[12:15], s49 offen lds
    s_add_u32 m0, s42, 132096
    s_add_u32 s49, s51, 32768
    buffer_load_dwordx4 v3, s[12:15], s49 offen lds
    s_add_u32 m0, s42, 133120
    s_add_u32 s49, s51, 65536
    buffer_load_dwordx4 v4, s[12:15], s49 offen lds
    s_add_u32 m0, s42, 134144
    s_add_u32 s49, s51, 98304
    buffer_load_dwordx4 v4, s[12:15], s49 offen lds
    s_add_u32 s51, s51, 262144
    s_cmp_ge_u32 s51, 5242880
    s_cselect_b32 s51, 0, s51
    s_add_u32 m0, s43, 104448
    s_add_u32 s49, s52, 61440
    buffer_load_dwordx4 v1, s[8:11], s49 offen lds
    s_add_u32 m0, s43, 105472
    s_add_u32 s49, s52, 71680
    buffer_load_dwordx4 v2, s[8:11], s49 offen lds
    s_add_u32 m0, s43, 106496
    s_add_u32 s49, s52, 81920
    buffer_load_dwordx4 v1, s[8:11], s49 offen lds
    s_add_u32 m0, s43, 107520
    s_add_u32 s49, s52, 92160
    buffer_load_dwordx4 v2, s[8:11], s49 offen lds
    s_add_u32 m0, s43, 108544
    s_add_u32 s49, s52, 102400
    buffer_load_dwordx4 v1, s[8:11], s49 offen lds
    s_add_u32 m0, s43, 109568
    s_add_u32 s49, s52, 112640
    buffer_load_dwordx4 v2, s[8:11], s49 offen lds
    s_add_u32 s52, s52, 128
    s_cmp_ge_u32 s52, 1280
    s_cselect_b32 s52, 0, s52
    s_waitcnt vmcnt(20)
    s_barrier
    s_add_u32 m0, s42, 139264
    s_add_u32 s49, s51, 0
    buffer_load_dwordx4 v3, s[12:15], s49 offen lds
    s_add_u32 m0, s42, 140288
    s_add_u32 s49, s51, 32768
    buffer_load_dwordx4 v3, s[12:15], s49 offen lds
    s_add_u32 m0, s42, 141312
    s_add_u32 s49, s51, 65536
    buffer_load_dwordx4 v4, s[12:15], s49 offen lds
    s_add_u32 m0, s42, 142336
    s_add_u32 s49, s51, 98304
    buffer_load_dwordx4 v4, s[12:15], s49 offen lds
    s_add_u32 s51, s51, 262144
    s_cmp_ge_u32 s51, 5242880
    s_cselect_b32 s51, 0, s51
    s_add_u32 m0, s43, 49152
    s_add_u32 s49, s52, 0
    buffer_load_dwordx4 v1, s[8:11], s49 offen lds
    s_add_u32 m0, s43, 50176
    s_add_u32 s49, s52, 10240
    buffer_load_dwordx4 v2, s[8:11], s49 offen lds
    s_add_u32 m0, s43, 51200
    s_add_u32 s49, s52, 20480
    buffer_load_dwordx4 v1, s[8:11], s49 offen lds
    s_add_u32 m0, s43, 52224
    s_add_u32 s49, s52, 30720
    buffer_load_dwordx4 v2, s[8:11], s49 offen lds
    s_add_u32 m0, s43, 53248
    s_add_u32 s49, s52, 40960
    buffer_load_dwordx4 v1, s[8:11], s49 offen lds
    s_add_u32 m0, s43, 54272
    s_add_u32 s49, s52, 51200
    buffer_load_dwordx4 v2, s[8:11], s49 offen lds
    s_barrier
    s_add_u32 m0, s42, 147456
    s_add_u32 s49, s51, 0
    buffer_load_dwordx4 v3, s[12:15], s49 offen lds
    s_add_u32 m0, s42, 148480
    s_add_u32 s49, s51, 32768
    buffer_load_dwordx4 v3, s[12:15], s49 offen lds
    s_add_u32 m0, s42, 149504
    s_add_u32 s49, s51, 65536
    buffer_load_dwordx4 v4, s[12:15], s49 offen lds
    s_add_u32 m0, s42, 150528
    s_add_u32 s49, s51, 98304
    buffer_load_dwordx4 v4, s[12:15], s49 offen lds
    s_add_u32 s51, s51, 262144
    s_cmp_ge_u32 s51, 5242880
    s_cselect_b32 s51, 0, s51
    s_add_u32 m0, s43, 55296
    s_add_u32 s49, s52, 61440
    buffer_load_dwordx4 v1, s[8:11], s49 offen lds
    s_add_u32 m0, s43, 56320
    s_add_u32 s49, s52, 71680
    buffer_load_dwordx4 v2, s[8:11], s49 offen lds
    s_add_u32 m0, s43, 57344
    s_add_u32 s49, s52, 81920
    buffer_load_dwordx4 v1, s[8:11], s49 offen lds
    s_add_u32 m0, s43, 58368
    s_add_u32 s49, s52, 92160
    buffer_load_dwordx4 v2, s[8:11], s49 offen lds
    s_add_u32 m0, s43, 59392
    s_add_u32 s49, s52, 102400
    buffer_load_dwordx4 v1, s[8:11], s49 offen lds
    s_add_u32 m0, s43, 60416
    s_add_u32 s49, s52, 112640
    buffer_load_dwordx4 v2, s[8:11], s49 offen lds
    s_add_u32 s52, s52, 128
    s_cmp_ge_u32 s52, 1280
    s_cselect_b32 s52, 0, s52
    s_waitcnt vmcnt(20)
    s_barrier
    s_add_u32 m0, s42, 155648
    s_add_u32 s49, s51, 0
    buffer_load_dwordx4 v3, s[12:15], s49 offen lds
    s_add_u32 m0, s42, 156672
    s_add_u32 s49, s51, 32768
    buffer_load_dwordx4 v3, s[12:15], s49 offen lds
    s_add_u32 m0, s42, 157696
    s_add_u32 s49, s51, 65536
    buffer_load_dwordx4 v4, s[12:15], s49 offen lds
    s_add_u32 m0, s42, 158720
    s_add_u32 s49, s51, 98304
    buffer_load_dwordx4 v4, s[12:15], s49 offen lds
    s_add_u32 s51, s51, 262144
    s_cmp_ge_u32 s51, 5242880
    s_cselect_b32 s51, 0, s51
    s_add_u32 m0, s43, 73728
    s_add_u32 s49, s52, 0
    buffer_load_dwordx4 v1, s[8:11], s49 offen lds
    s_add_u32 m0, s43, 74752
    s_add_u32 s49, s52, 10240
    buffer_load_dwordx4 v2, s[8:11], s49 offen lds
    s_add_u32 m0, s43, 75776
    s_add_u32 s49, s52, 20480
    buffer_load_dwordx4 v1, s[8:11], s49 offen lds
    s_add_u32 m0, s43, 76800
    s_add_u32 s49, s52, 30720
    buffer_load_dwordx4 v2, s[8:11], s49 offen lds
    s_add_u32 m0, s43, 77824
    s_add_u32 s49, s52, 40960
    buffer_load_dwordx4 v1, s[8:11], s49 offen lds
    s_add_u32 m0, s43, 78848
    s_add_u32 s49, s52, 51200
    buffer_load_dwordx4 v2, s[8:11], s49 offen lds
    s_barrier
    s_add_u32 m0, s42, 122880
    s_add_u32 s49, s51, 0
    buffer_load_dwordx4 v3, s[12:15], s49 offen lds
    s_add_u32 m0, s42, 123904
    s_add_u32 s49, s51, 32768
    buffer_load_dwordx4 v3, s[12:15], s49 offen lds
    s_add_u32 m0, s42, 124928
    s_add_u32 s49, s51, 65536
    buffer_load_dwordx4 v4, s[12:15], s49 offen lds
    s_add_u32 m0, s42, 125952
    s_add_u32 s49, s51, 98304
    buffer_load_dwordx4 v4, s[12:15], s49 offen lds
    s_add_u32 s51, s51, 262144
    s_cmp_ge_u32 s51, 5242880
    s_cselect_b32 s51, 0, s51
    s_add_u32 m0, s43, 79872
    s_add_u32 s49, s52, 61440
    buffer_load_dwordx4 v1, s[8:11], s49 offen lds
    s_add_u32 m0, s43, 80896
    s_add_u32 s49, s52, 71680
    buffer_load_dwordx4 v2, s[8:11], s49 offen lds
    s_add_u32 m0, s43, 81920
    s_add_u32 s49, s52, 81920
    buffer_load_dwordx4 v1, s[8:11], s49 offen lds
    s_add_u32 m0, s43, 82944
    s_add_u32 s49, s52, 92160
    buffer_load_dwordx4 v2, s[8:11], s49 offen lds
    s_add_u32 m0, s43, 83968
    s_add_u32 s49, s52, 102400
    buffer_load_dwordx4 v1, s[8:11], s49 offen lds
    s_add_u32 m0, s43, 84992
    s_add_u32 s49, s52, 112640
    buffer_load_dwordx4 v2, s[8:11], s49 offen lds
    s_add_u32 s52, s52, 128
    s_cmp_ge_u32 s52, 1280
    s_cselect_b32 s52, 0, s52
    s_waitcnt vmcnt(20)
    s_barrier
    s_add_u32 m0, s42, 131072
    s_add_u32 s49, s51, 0
    buffer_load_dwordx4 v3, s[12:15], s49 offen lds
    s_add_u32 m0, s42, 132096
    s_add_u32 s49, s51, 32768
    buffer_load_dwordx4 v3, s[12:15], s49 offen lds
    s_add_u32 m0, s42, 133120
    s_add_u32 s49, s51, 65536
    buffer_load_dwordx4 v4, s[12:15], s49 offen lds
    s_add_u32 m0, s42, 134144
    s_add_u32 s49, s51, 98304
    buffer_load_dwordx4 v4, s[12:15], s49 offen lds
    s_add_u32 s51, s51, 262144
    s_cmp_ge_u32 s51, 5242880
    s_cselect_b32 s51, 0, s51
    s_add_u32 m0, s43, 98304
    s_add_u32 s49, s52, 0
    buffer_load_dwordx4 v1, s[8:11], s49 offen lds
    s_add_u32 m0, s43, 99328
    s_add_u32 s49, s52, 10240
    buffer_load_dwordx4 v2, s[8:11], s49 offen lds
    s_add_u32 m0, s43, 100352
    s_add_u32 s49, s52, 20480
    buffer_load_dwordx4 v1, s[8:11], s49 offen lds
    s_add_u32 m0, s43, 101376
    s_add_u32 s49, s52, 30720
    buffer_load_dwordx4 v2, s[8:11], s49 offen lds
    s_add_u32 m0, s43, 102400
    s_add_u32 s49, s52, 40960
    buffer_load_dwordx4 v1, s[8:11], s49 offen lds
    s_add_u32 m0, s43, 103424
    s_add_u32 s49, s52, 51200
    buffer_load_dwordx4 v2, s[8:11], s49 offen lds
    s_barrier
    s_add_u32 m0, s42, 139264
    s_add_u32 s49, s51, 0
    buffer_load_dwordx4 v3, s[12:15], s49 offen lds
    s_add_u32 m0, s42, 140288
    s_add_u32 s49, s51, 32768
    buffer_load_dwordx4 v3, s[12:15], s49 offen lds
    s_add_u32 m0, s42, 141312
    s_add_u32 s49, s51, 65536
    buffer_load_dwordx4 v4, s[12:15], s49 offen lds
    s_add_u32 m0, s42, 142336
    s_add_u32 s49, s51, 98304
    buffer_load_dwordx4 v4, s[12:15], s49 offen lds
    s_add_u32 s51, s51, 262144
    s_cmp_ge_u32 s51, 5242880
    s_cselect_b32 s51, 0, s51
    s_add_u32 m0, s43, 104448
    s_add_u32 s49, s52, 61440
    buffer_load_dwordx4 v1, s[8:11], s49 offen lds
    s_add_u32 m0, s43, 105472
    s_add_u32 s49, s52, 71680
    buffer_load_dwordx4 v2, s[8:11], s49 offen lds
    s_add_u32 m0, s43, 106496
    s_add_u32 s49, s52, 81920
    buffer_load_dwordx4 v1, s[8:11], s49 offen lds
    s_add_u32 m0, s43, 107520
    s_add_u32 s49, s52, 92160
    buffer_load_dwordx4 v2, s[8:11], s49 offen lds
    s_add_u32 m0, s43, 108544
    s_add_u32 s49, s52, 102400
    buffer_load_dwordx4 v1, s[8:11], s49 offen lds
    s_add_u32 m0, s43, 109568
    s_add_u32 s49, s52, 112640
    buffer_load_dwordx4 v2, s[8:11], s49 offen lds
    s_add_u32 s52, s52, 128
    s_cmp_ge_u32 s52, 1280
    s_cselect_b32 s52, 0, s52
    s_waitcnt vmcnt(20)
    s_barrier
    s_add_u32 m0, s42, 147456
    s_add_u32 s49, s51, 0
    buffer_load_dwordx4 v3, s[12:15], s49 offen lds
    s_add_u32 m0, s42, 148480
    s_add_u32 s49, s51, 32768
    buffer_load_dwordx4 v3, s[12:15], s49 offen lds
    s_add_u32 m0, s42, 149504
    s_add_u32 s49, s51, 65536
    buffer_load_dwordx4 v4, s[12:15], s49 offen lds
    s_add_u32 m0, s42, 150528
    s_add_u32 s49, s51, 98304
    buffer_load_dwordx4 v4, s[12:15], s49 offen lds
    s_add_u32 s51, s51, 262144
    s_cmp_ge_u32 s51, 5242880
    s_cselect_b32 s51, 0, s51
    s_add_u32 m0, s43, 49152
    s_add_u32 s49, s52, 0
    buffer_load_dwordx4 v1, s[8:11], s49 offen lds
    s_add_u32 m0, s43, 50176
    s_add_u32 s49, s52, 10240
    buffer_load_dwordx4 v2, s[8:11], s49 offen lds
    s_add_u32 m0, s43, 51200
    s_add_u32 s49, s52, 20480
    buffer_load_dwordx4 v1, s[8:11], s49 offen lds
    s_add_u32 m0, s43, 52224
    s_add_u32 s49, s52, 30720
    buffer_load_dwordx4 v2, s[8:11], s49 offen lds
    s_add_u32 m0, s43, 53248
    s_add_u32 s49, s52, 40960
    buffer_load_dwordx4 v1, s[8:11], s49 offen lds
    s_add_u32 m0, s43, 54272
    s_add_u32 s49, s52, 51200
    buffer_load_dwordx4 v2, s[8:11], s49 offen lds
    s_barrier
    s_add_u32 m0, s42, 155648
    s_add_u32 s49, s51, 0
    buffer_load_dwordx4 v3, s[12:15], s49 offen lds
    s_add_u32 m0, s42, 156672
    s_add_u32 s49, s51, 32768
    buffer_load_dwordx4 v3, s[12:15], s49 offen lds
    s_add_u32 m0, s42, 157696
    s_add_u32 s49, s51, 65536
    buffer_load_dwordx4 v4, s[12:15], s49 offen lds
    s_add_u32 m0, s42, 158720
    s_add_u32 s49, s51, 98304
    buffer_load_dwordx4 v4, s[12:15], s49 offen lds
    s_add_u32 s51, s51, 262144
    s_cmp_ge_u32 s51, 5242880
    s_cselect_b32 s51, 0, s51
    s_add_u32 m0, s43, 55296
    s_add_u32 s49, s52, 61440
    buffer_load_dwordx4 v1, s[8:11], s49 offen lds
    s_add_u32 m0, s43, 56320
    s_add_u32 s49, s52, 71680
    buffer_load_dwordx4 v2, s[8:11], s49 offen lds
    s_add_u32 m0, s43, 57344
    s_add_u32 s49, s52, 81920
    buffer_load_dwordx4 v1, s[8:11], s49 offen lds
    s_add_u32 m0, s43, 58368
    s_add_u32 s49, s52, 92160
    buffer_load_dwordx4 v2, s[8:11], s49 offen lds
    s_add_u32 m0, s43, 59392
    s_add_u32 s49, s52, 102400
    buffer_load_dwordx4 v1, s[8:11], s49 offen lds
    s_add_u32 m0, s43, 60416
    s_add_u32 s49, s52, 112640
    buffer_load_dwordx4 v2, s[8:11], s49 offen lds
    s_add_u32 s52, s52, 128
    s_cmp_ge_u32 s52, 1280
    s_cselect_b32 s52, 0, s52
    s_waitcnt vmcnt(20)
    s_barrier
    s_barrier
    s_waitcnt vmcnt(0)
    s_barrier
    s_barrier
    s_barrier
    s_cmp_ge_u32 s4, 30
    s_cbranch_scc1 L_done
    s_mul_i32 s60, s4, 52
    s_lshr_b32 s60, s60, 8
    s_mul_i32 s61, s60, 5
    s_sub_u32 s61, s4, s61
    s_and_b32 s62, s3, 3
    s_add_u32 s76, s36, 15728640
    s_addc_u32 s77, s37, 0
    s_mov_b32 s78, 0x20000
    s_mov_b32 s79, 0x00020000
    s_mul_i32 s40, s62, 1310720
    s_lshl_b32 s41, s61, 8
    s_add_u32 s40, s40, s41
    s_add_u32 s64, s56, s40
    s_addc_u32 s65, s57, 0
    s_sub_u32 s66, 5242880, s40
    s_mov_b32 s67, 0x00020000
    s_mul_i32 s40, s3, 48
    s_lshl_b32 s41, s60, 3
    s_add_u32 s40, s40, s41
    s_lshl_b32 s40, s40, 15
    s_add_u32 s68, s36, s40
    s_addc_u32 s69, s37, 0
    s_sub_u32 s70, 12582912, s40
    s_mov_b32 s71, 0x00020000
    v_lshlrev_b32 v112, 1, v109
    v_xor_b32 v112, v112, v108
    v_lshlrev_b32 v112, 4, v112
    v_mul_u32_u24 v113, 1280, v109
    v_add_u32 v1, v112, v113
    v_xor_b32 v2, 128, v1
    s_lshl_b32 s42, s38, 13
    s_mul_i32 s43, s38, 40960
    s_lshl_b32 s46, s38, 17
    s_barrier
    s_add_u32 m0, s42, 0
    s_add_u32 s47, s43, 0
    buffer_load_dwordx4 v1, s[64:67], s47 offen lds
    s_add_u32 m0, s42, 1024
    s_add_u32 s47, s43, 5120
    buffer_load_dwordx4 v2, s[64:67], s47 offen lds
    s_add_u32 m0, s42, 2048
    s_add_u32 s47, s43, 10240
    buffer_load_dwordx4 v1, s[64:67], s47 offen lds
    s_add_u32 m0, s42, 3072
    s_add_u32 s47, s43, 15360
    buffer_load_dwordx4 v2, s[64:67], s47 offen lds
    s_add_u32 m0, s42, 4096
    s_add_u32 s47, s43, 20480
    buffer_load_dwordx4 v1, s[64:67], s47 offen lds
    s_add_u32 m0, s42, 5120
    s_add_u32 s47, s43, 25600
    buffer_load_dwordx4 v2, s[64:67], s47 offen lds
    s_add_u32 m0, s42, 6144
    s_add_u32 s47, s43, 30720
    buffer_load_dwordx4 v1, s[64:67], s47 offen lds
    s_add_u32 m0, s42, 7168
    s_add_u32 s47, s43, 35840
    buffer_load_dwordx4 v2, s[64:67], s47 offen lds
    s_add_u32 m0, s42, 16384
    s_add_u32 s47, s43, 81920
    buffer_load_dwordx4 v1, s[64:67], s47 offen lds
    s_add_u32 m0, s42, 17408
    s_add_u32 s47, s43, 87040
    buffer_load_dwordx4 v2, s[64:67], s47 offen lds
    s_add_u32 m0, s42, 18432
    s_add_u32 s47, s43, 92160
    buffer_load_dwordx4 v1, s[64:67], s47 offen lds
    s_add_u32 m0, s42, 19456
    s_add_u32 s47, s43, 97280
    buffer_load_dwordx4 v2, s[64:67], s47 offen lds
    s_add_u32 m0, s42, 20480
    s_add_u32 s47, s43, 102400
    buffer_load_dwordx4 v1, s[64:67], s47 offen lds
    s_add_u32 m0, s42, 21504
    s_add_u32 s47, s43, 107520
    buffer_load_dwordx4 v2, s[64:67], s47 offen lds
    s_add_u32 m0, s42, 22528
    s_add_u32 s47, s43, 112640
    buffer_load_dwordx4 v1, s[64:67], s47 offen lds
    s_add_u32 m0, s42, 23552
    s_add_u32 s47, s43, 117760
    buffer_load_dwordx4 v2, s[64:67], s47 offen lds
    s_add_u32 m0, s42, 32768
    s_add_u32 s47, s43, 163840
    buffer_load_dwordx4 v1, s[64:67], s47 offen lds
    s_add_u32 m0, s42, 33792
    s_add_u32 s47, s43, 168960
    buffer_load_dwordx4 v2, s[64:67], s47 offen lds
    s_add_u32 m0, s42, 34816
    s_add_u32 s47, s43, 174080
    buffer_load_dwordx4 v1, s[64:67], s47 offen lds
    s_add_u32 m0, s42, 35840
    s_add_u32 s47, s43, 179200
    buffer_load_dwordx4 v2, s[64:67], s47 offen lds
    s_add_u32 m0, s42, 36864
    s_add_u32 s47, s43, 184320
    buffer_load_dwordx4 v1, s[64:67], s47 offen lds
    s_add_u32 m0, s42, 37888
    s_add_u32 s47, s43, 189440
    buffer_load_dwordx4 v2, s[64:67], s47 offen lds
    s_add_u32 m0, s42, 38912
    s_add_u32 s47, s43, 194560
    buffer_load_dwordx4 v1, s[64:67], s47 offen lds
    s_add_u32 m0, s42, 39936
    s_add_u32 s47, s43, 199680
    buffer_load_dwordx4 v2, s[64:67], s47 offen lds
    s_barrier
    s_add_u32 m0, s42, 65536
    s_add_u32 s47, s46, 0
    buffer_load_dwordx4 v107, s[68:71], s47 offen sc1 lds
    s_add_u32 m0, s42, 67584
    s_add_u32 s47, s46, 32768
    buffer_load_dwordx4 v107, s[68:71], s47 offen sc1 lds
    s_add_u32 m0, s42, 69632
    s_add_u32 s47, s46, 65536
    buffer_load_dwordx4 v107, s[68:71], s47 offen sc1 lds
    s_add_u32 m0, s42, 71680
    s_add_u32 s47, s46, 98304
    buffer_load_dwordx4 v107, s[68:71], s47 offen sc1 lds
    s_add_u32 m0, s42, 66560
    s_add_u32 s47, s46, 1024
    buffer_load_dwordx4 v107, s[68:71], s47 offen sc1 lds
    s_add_u32 m0, s42, 68608
    s_add_u32 s47, s46, 33792
    buffer_load_dwordx4 v107, s[68:71], s47 offen sc1 lds
    s_add_u32 m0, s42, 70656
    s_add_u32 s47, s46, 66560
    buffer_load_dwordx4 v107, s[68:71], s47 offen sc1 lds
    s_add_u32 m0, s42, 72704
    s_add_u32 s47, s46, 99328
    buffer_load_dwordx4 v107, s[68:71], s47 offen sc1 lds
    s_add_u32 m0, s42, 81920
    s_add_u32 s47, s46, 2048
    buffer_load_dwordx4 v107, s[68:71], s47 offen sc1 lds
    s_add_u32 m0, s42, 83968
    s_add_u32 s47, s46, 34816
    buffer_load_dwordx4 v107, s[68:71], s47 offen sc1 lds
    s_add_u32 m0, s42, 86016
    s_add_u32 s47, s46, 67584
    buffer_load_dwordx4 v107, s[68:71], s47 offen sc1 lds
    s_add_u32 m0, s42, 88064
    s_add_u32 s47, s46, 100352
    buffer_load_dwordx4 v107, s[68:71], s47 offen sc1 lds
    s_add_u32 m0, s42, 82944
    s_add_u32 s47, s46, 3072
    buffer_load_dwordx4 v107, s[68:71], s47 offen sc1 lds
    s_add_u32 m0, s42, 84992
    s_add_u32 s47, s46, 35840
    buffer_load_dwordx4 v107, s[68:71], s47 offen sc1 lds
    s_add_u32 m0, s42, 87040
    s_add_u32 s47, s46, 68608
    buffer_load_dwordx4 v107, s[68:71], s47 offen sc1 lds
    s_add_u32 m0, s42, 89088
    s_add_u32 s47, s46, 101376
    buffer_load_dwordx4 v107, s[68:71], s47 offen sc1 lds
    s_barrier
    s_add_u32 m0, s42, 98304
    s_add_u32 s47, s46, 4096
    buffer_load_dwordx4 v107, s[68:71], s47 offen sc1 lds
    s_add_u32 m0, s42, 100352
    s_add_u32 s47, s46, 36864
    buffer_load_dwordx4 v107, s[68:71], s47 offen sc1 lds
    s_add_u32 m0, s42, 102400
    s_add_u32 s47, s46, 69632
    buffer_load_dwordx4 v107, s[68:71], s47 offen sc1 lds
    s_add_u32 m0, s42, 104448
    s_add_u32 s47, s46, 102400
    buffer_load_dwordx4 v107, s[68:71], s47 offen sc1 lds
    s_add_u32 m0, s42, 99328
    s_add_u32 s47, s46, 5120
    buffer_load_dwordx4 v107, s[68:71], s47 offen sc1 lds
    s_add_u32 m0, s42, 101376
    s_add_u32 s47, s46, 37888
    buffer_load_dwordx4 v107, s[68:71], s47 offen sc1 lds
    s_add_u32 m0, s42, 103424
    s_add_u32 s47, s46, 70656
    buffer_load_dwordx4 v107, s[68:71], s47 offen sc1 lds
    s_add_u32 m0, s42, 105472
    s_add_u32 s47, s46, 103424
    buffer_load_dwordx4 v107, s[68:71], s47 offen sc1 lds
    s_waitcnt vmcnt(16)
    s_barrier
    s_add_u32 m0, s42, 114688
    s_add_u32 s47, s46, 6144
    buffer_load_dwordx4 v107, s[68:71], s47 offen sc1 lds
    s_add_u32 m0, s42, 116736
    s_add_u32 s47, s46, 38912
    buffer_load_dwordx4 v107, s[68:71], s47 offen sc1 lds
    s_add_u32 m0, s42, 118784
    s_add_u32 s47, s46, 71680
    buffer_load_dwordx4 v107, s[68:71], s47 offen sc1 lds
    s_add_u32 m0, s42, 120832
    s_add_u32 s47, s46, 104448
    buffer_load_dwordx4 v107, s[68:71], s47 offen sc1 lds
    s_add_u32 m0, s42, 115712
    s_add_u32 s47, s46, 7168
    buffer_load_dwordx4 v107, s[68:71], s47 offen sc1 lds
    s_add_u32 m0, s42, 117760
    s_add_u32 s47, s46, 39936
    buffer_load_dwordx4 v107, s[68:71], s47 offen sc1 lds
    s_add_u32 m0, s42, 119808
    s_add_u32 s47, s46, 72704
    buffer_load_dwordx4 v107, s[68:71], s47 offen sc1 lds
    s_add_u32 m0, s42, 121856
    s_add_u32 s47, s46, 105472
    buffer_load_dwordx4 v107, s[68:71], s47 offen sc1 lds
    s_add_u32 m0, s42, 49152
    s_add_u32 s47, s43, 245760
    buffer_load_dwordx4 v1, s[64:67], s47 offen lds
    s_add_u32 m0, s42, 50176
    s_add_u32 s47, s43, 250880
    buffer_load_dwordx4 v2, s[64:67], s47 offen lds
    s_add_u32 m0, s42, 51200
    s_add_u32 s47, s43, 256000
    buffer_load_dwordx4 v1, s[64:67], s47 offen lds
    s_add_u32 m0, s42, 52224
    s_add_u32 s47, s43, 261120
    buffer_load_dwordx4 v2, s[64:67], s47 offen lds
    s_add_u32 m0, s42, 53248
    s_add_u32 s47, s43, 266240
    buffer_load_dwordx4 v1, s[64:67], s47 offen lds
    s_add_u32 m0, s42, 54272
    s_add_u32 s47, s43, 271360
    buffer_load_dwordx4 v2, s[64:67], s47 offen lds
    s_add_u32 m0, s42, 55296
    s_add_u32 s47, s43, 276480
    buffer_load_dwordx4 v1, s[64:67], s47 offen lds
    s_add_u32 m0, s42, 56320
    s_add_u32 s47, s43, 281600
    buffer_load_dwordx4 v2, s[64:67], s47 offen lds
    s_waitcnt vmcnt(24)
    s_barrier
    s_add_u32 m0, s42, 65536
    s_add_u32 s47, s46, 8192
    buffer_load_dwordx4 v107, s[68:71], s47 offen sc1 lds
    s_add_u32 m0, s42, 67584
    s_add_u32 s47, s46, 40960
    buffer_load_dwordx4 v107, s[68:71], s47 offen sc1 lds
    s_add_u32 m0, s42, 69632
    s_add_u32 s47, s46, 73728
    buffer_load_dwordx4 v107, s[68:71], s47 offen sc1 lds
    s_add_u32 m0, s42, 71680
    s_add_u32 s47, s46, 106496
    buffer_load_dwordx4 v107, s[68:71], s47 offen sc1 lds
    s_add_u32 m0, s42, 66560
    s_add_u32 s47, s46, 9216
    buffer_load_dwordx4 v107, s[68:71], s47 offen sc1 lds
    s_add_u32 m0, s42, 68608
    s_add_u32 s47, s46, 41984
    buffer_load_dwordx4 v107, s[68:71], s47 offen sc1 lds
    s_add_u32 m0, s42, 70656
    s_add_u32 s47, s46, 74752
    buffer_load_dwordx4 v107, s[68:71], s47 offen sc1 lds
    s_add_u32 m0, s42, 72704
    s_add_u32 s47, s46, 107520
    buffer_load_dwordx4 v107, s[68:71], s47 offen sc1 lds
    s_add_u32 m0, s42, 0
    s_add_u32 s47, s43, 327680
    buffer_load_dwordx4 v1, s[64:67], s47 offen lds
    s_add_u32 m0, s42, 1024
    s_add_u32 s47, s43, 332800
    buffer_load_dwordx4 v2, s[64:67], s47 offen lds
    s_add_u32 m0, s42, 2048
    s_add_u32 s47, s43, 337920
    buffer_load_dwordx4 v1, s[64:67], s47 offen lds
    s_add_u32 m0, s42, 3072
    s_add_u32 s47, s43, 343040
    buffer_load_dwordx4 v2, s[64:67], s47 offen lds
    s_add_u32 m0, s42, 4096
    s_add_u32 s47, s43, 348160
    buffer_load_dwordx4 v1, s[64:67], s47 offen lds
    s_add_u32 m0, s42, 5120
    s_add_u32 s47, s43, 353280
    buffer_load_dwordx4 v2, s[64:67], s47 offen lds
    s_add_u32 m0, s42, 6144
    s_add_u32 s47, s43, 358400
    buffer_load_dwordx4 v1, s[64:67], s47 offen lds
    s_add_u32 m0, s42, 7168
    s_add_u32 s47, s43, 363520
    buffer_load_dwordx4 v2, s[64:67], s47 offen lds
    s_waitcnt vmcnt(32)
    s_barrier
    s_add_u32 m0, s42, 81920
    s_add_u32 s47, s46, 10240
    buffer_load_dwordx4 v107, s[68:71], s47 offen sc1 lds
    s_add_u32 m0, s42, 83968
    s_add_u32 s47, s46, 43008
    buffer_load_dwordx4 v107, s[68:71], s47 offen sc1 lds
    s_add_u32 m0, s42, 86016
    s_add_u32 s47, s46, 75776
    buffer_load_dwordx4 v107, s[68:71], s47 offen sc1 lds
    s_add_u32 m0, s42, 88064
    s_add_u32 s47, s46, 108544
    buffer_load_dwordx4 v107, s[68:71], s47 offen sc1 lds
    s_add_u32 m0, s42, 82944
    s_add_u32 s47, s46, 11264
    buffer_load_dwordx4 v107, s[68:71], s47 offen sc1 lds
    s_add_u32 m0, s42, 84992
    s_add_u32 s47, s46, 44032
    buffer_load_dwordx4 v107, s[68:71], s47 offen sc1 lds
    s_add_u32 m0, s42, 87040
    s_add_u32 s47, s46, 76800
    buffer_load_dwordx4 v107, s[68:71], s47 offen sc1 lds
    s_add_u32 m0, s42, 89088
    s_add_u32 s47, s46, 109568
    buffer_load_dwordx4 v107, s[68:71], s47 offen sc1 lds
    s_add_u32 m0, s42, 16384
    s_add_u32 s47, s43, 409600
    buffer_load_dwordx4 v1, s[64:67], s47 offen lds
    s_add_u32 m0, s42, 17408
    s_add_u32 s47, s43, 414720
    buffer_load_dwordx4 v2, s[64:67], s47 offen lds
    s_add_u32 m0, s42, 18432
    s_add_u32 s47, s43, 419840
    buffer_load_dwordx4 v1, s[64:67], s47 offen lds
    s_add_u32 m0, s42, 19456
    s_add_u32 s47, s43, 424960
    buffer_load_dwordx4 v2, s[64:67], s47 offen lds
    s_add_u32 m0, s42, 20480
    s_add_u32 s47, s43, 430080
    buffer_load_dwordx4 v1, s[64:67], s47 offen lds
    s_add_u32 m0, s42, 21504
    s_add_u32 s47, s43, 435200
    buffer_load_dwordx4 v2, s[64:67], s47 offen lds
    s_add_u32 m0, s42, 22528
    s_add_u32 s47, s43, 440320
    buffer_load_dwordx4 v1, s[64:67], s47 offen lds
    s_add_u32 m0, s42, 23552
    s_add_u32 s47, s43, 445440
    buffer_load_dwordx4 v2, s[64:67], s47 offen lds
    s_waitcnt vmcnt(32)
    s_barrier
    s_add_u32 m0, s42, 98304
    s_add_u32 s47, s46, 12288
    buffer_load_dwordx4 v107, s[68:71], s47 offen sc1 lds
    s_add_u32 m0, s42, 100352
    s_add_u32 s47, s46, 45056
    buffer_load_dwordx4 v107, s[68:71], s47 offen sc1 lds
    s_add_u32 m0, s42, 102400
    s_add_u32 s47, s46, 77824
    buffer_load_dwordx4 v107, s[68:71], s47 offen sc1 lds
    s_add_u32 m0, s42, 104448
    s_add_u32 s47, s46, 110592
    buffer_load_dwordx4 v107, s[68:71], s47 offen sc1 lds
    s_add_u32 m0, s42, 99328
    s_add_u32 s47, s46, 13312
    buffer_load_dwordx4 v107, s[68:71], s47 offen sc1 lds
    s_add_u32 m0, s42, 101376
    s_add_u32 s47, s46, 46080
    buffer_load_dwordx4 v107, s[68:71], s47 offen sc1 lds
    s_add_u32 m0, s42, 103424
    s_add_u32 s47, s46, 78848
    buffer_load_dwordx4 v107, s[68:71], s47 offen sc1 lds
    s_add_u32 m0, s42, 105472
    s_add_u32 s47, s46, 111616
    buffer_load_dwordx4 v107, s[68:71], s47 offen sc1 lds
    s_add_u32 m0, s42, 32768
    s_add_u32 s47, s43, 491520
    buffer_load_dwordx4 v1, s[64:67], s47 offen lds
    s_add_u32 m0, s42, 33792
    s_add_u32 s47, s43, 496640
    buffer_load_dwordx4 v2, s[64:67], s47 offen lds
    s_add_u32 m0, s42, 34816
    s_add_u32 s47, s43, 501760
    buffer_load_dwordx4 v1, s[64:67], s47 offen lds
    s_add_u32 m0, s42, 35840
    s_add_u32 s47, s43, 506880
    buffer_load_dwordx4 v2, s[64:67], s47 offen lds
    s_add_u32 m0, s42, 36864
    s_add_u32 s47, s43, 512000
    buffer_load_dwordx4 v1, s[64:67], s47 offen lds
    s_add_u32 m0, s42, 37888
    s_add_u32 s47, s43, 517120
    buffer_load_dwordx4 v2, s[64:67], s47 offen lds
    s_add_u32 m0, s42, 38912
    s_add_u32 s47, s43, 522240
    buffer_load_dwordx4 v1, s[64:67], s47 offen lds
    s_add_u32 m0, s42, 39936
    s_add_u32 s47, s43, 527360
    buffer_load_dwordx4 v2, s[64:67], s47 offen lds
    s_waitcnt vmcnt(32)
    s_barrier
    s_add_u32 m0, s42, 114688
    s_add_u32 s47, s46, 14336
    buffer_load_dwordx4 v107, s[68:71], s47 offen sc1 lds
    s_add_u32 m0, s42, 116736
    s_add_u32 s47, s46, 47104
    buffer_load_dwordx4 v107, s[68:71], s47 offen sc1 lds
    s_add_u32 m0, s42, 118784
    s_add_u32 s47, s46, 79872
    buffer_load_dwordx4 v107, s[68:71], s47 offen sc1 lds
    s_add_u32 m0, s42, 120832
    s_add_u32 s47, s46, 112640
    buffer_load_dwordx4 v107, s[68:71], s47 offen sc1 lds
    s_add_u32 m0, s42, 115712
    s_add_u32 s47, s46, 15360
    buffer_load_dwordx4 v107, s[68:71], s47 offen sc1 lds
    s_add_u32 m0, s42, 117760
    s_add_u32 s47, s46, 48128
    buffer_load_dwordx4 v107, s[68:71], s47 offen sc1 lds
    s_add_u32 m0, s42, 119808
    s_add_u32 s47, s46, 80896
    buffer_load_dwordx4 v107, s[68:71], s47 offen sc1 lds
    s_add_u32 m0, s42, 121856
    s_add_u32 s47, s46, 113664
    buffer_load_dwordx4 v107, s[68:71], s47 offen sc1 lds
    s_add_u32 m0, s42, 49152
    s_add_u32 s47, s43, 573440
    buffer_load_dwordx4 v1, s[64:67], s47 offen lds
    s_add_u32 m0, s42, 50176
    s_add_u32 s47, s43, 578560
    buffer_load_dwordx4 v2, s[64:67], s47 offen lds
    s_add_u32 m0, s42, 51200
    s_add_u32 s47, s43, 583680
    buffer_load_dwordx4 v1, s[64:67], s47 offen lds
    s_add_u32 m0, s42, 52224
    s_add_u32 s47, s43, 588800
    buffer_load_dwordx4 v2, s[64:67], s47 offen lds
    s_add_u32 m0, s42, 53248
    s_add_u32 s47, s43, 593920
    buffer_load_dwordx4 v1, s[64:67], s47 offen lds
    s_add_u32 m0, s42, 54272
    s_add_u32 s47, s43, 599040
    buffer_load_dwordx4 v2, s[64:67], s47 offen lds
    s_add_u32 m0, s42, 55296
    s_add_u32 s47, s43, 604160
    buffer_load_dwordx4 v1, s[64:67], s47 offen lds
    s_add_u32 m0, s42, 56320
    s_add_u32 s47, s43, 609280
    buffer_load_dwordx4 v2, s[64:67], s47 offen lds
    s_waitcnt vmcnt(32)
    s_barrier
    s_add_u32 m0, s42, 65536
    s_add_u32 s47, s46, 16384
    buffer_load_dwordx4 v107, s[68:71], s47 offen sc1 lds
    s_add_u32 m0, s42, 67584
    s_add_u32 s47, s46, 49152
    buffer_load_dwordx4 v107, s[68:71], s47 offen sc1 lds
    s_add_u32 m0, s42, 69632
    s_add_u32 s47, s46, 81920
    buffer_load_dwordx4 v107, s[68:71], s47 offen sc1 lds
    s_add_u32 m0, s42, 71680
    s_add_u32 s47, s46, 114688
    buffer_load_dwordx4 v107, s[68:71], s47 offen sc1 lds
    s_add_u32 m0, s42, 66560
    s_add_u32 s47, s46, 17408
    buffer_load_dwordx4 v107, s[68:71], s47 offen sc1 lds
    s_add_u32 m0, s42, 68608
    s_add_u32 s47, s46, 50176
    buffer_load_dwordx4 v107, s[68:71], s47 offen sc1 lds
    s_add_u32 m0, s42, 70656
    s_add_u32 s47, s46, 82944
    buffer_load_dwordx4 v107, s[68:71], s47 offen sc1 lds
    s_add_u32 m0, s42, 72704
    s_add_u32 s47, s46, 115712
    buffer_load_dwordx4 v107, s[68:71], s47 offen sc1 lds
    s_add_u32 m0, s42, 0
    s_add_u32 s47, s43, 655360
    buffer_load_dwordx4 v1, s[64:67], s47 offen lds
    s_add_u32 m0, s42, 1024
    s_add_u32 s47, s43, 660480
    buffer_load_dwordx4 v2, s[64:67], s47 offen lds
    s_add_u32 m0, s42, 2048
    s_add_u32 s47, s43, 665600
    buffer_load_dwordx4 v1, s[64:67], s47 offen lds
    s_add_u32 m0, s42, 3072
    s_add_u32 s47, s43, 670720
    buffer_load_dwordx4 v2, s[64:67], s47 offen lds
    s_add_u32 m0, s42, 4096
    s_add_u32 s47, s43, 675840
    buffer_load_dwordx4 v1, s[64:67], s47 offen lds
    s_add_u32 m0, s42, 5120
    s_add_u32 s47, s43, 680960
    buffer_load_dwordx4 v2, s[64:67], s47 offen lds
    s_add_u32 m0, s42, 6144
    s_add_u32 s47, s43, 686080
    buffer_load_dwordx4 v1, s[64:67], s47 offen lds
    s_add_u32 m0, s42, 7168
    s_add_u32 s47, s43, 691200
    buffer_load_dwordx4 v2, s[64:67], s47 offen lds
    s_waitcnt vmcnt(32)
    s_barrier
    s_add_u32 m0, s42, 81920
    s_add_u32 s47, s46, 18432
    buffer_load_dwordx4 v107, s[68:71], s47 offen sc1 lds
    s_add_u32 m0, s42, 83968
    s_add_u32 s47, s46, 51200
    buffer_load_dwordx4 v107, s[68:71], s47 offen sc1 lds
    s_add_u32 m0, s42, 86016
    s_add_u32 s47, s46, 83968
    buffer_load_dwordx4 v107, s[68:71], s47 offen sc1 lds
    s_add_u32 m0, s42, 88064
    s_add_u32 s47, s46, 116736
    buffer_load_dwordx4 v107, s[68:71], s47 offen sc1 lds
    s_add_u32 m0, s42, 82944
    s_add_u32 s47, s46, 19456
    buffer_load_dwordx4 v107, s[68:71], s47 offen sc1 lds
    s_add_u32 m0, s42, 84992
    s_add_u32 s47, s46, 52224
    buffer_load_dwordx4 v107, s[68:71], s47 offen sc1 lds
    s_add_u32 m0, s42, 87040
    s_add_u32 s47, s46, 84992
    buffer_load_dwordx4 v107, s[68:71], s47 offen sc1 lds
    s_add_u32 m0, s42, 89088
    s_add_u32 s47, s46, 117760
    buffer_load_dwordx4 v107, s[68:71], s47 offen sc1 lds
    s_add_u32 m0, s42, 16384
    s_add_u32 s47, s43, 737280
    buffer_load_dwordx4 v1, s[64:67], s47 offen lds
    s_add_u32 m0, s42, 17408
    s_add_u32 s47, s43, 742400
    buffer_load_dwordx4 v2, s[64:67], s47 offen lds
    s_add_u32 m0, s42, 18432
    s_add_u32 s47, s43, 747520
    buffer_load_dwordx4 v1, s[64:67], s47 offen lds
    s_add_u32 m0, s42, 19456
    s_add_u32 s47, s43, 752640
    buffer_load_dwordx4 v2, s[64:67], s47 offen lds
    s_add_u32 m0, s42, 20480
    s_add_u32 s47, s43, 757760
    buffer_load_dwordx4 v1, s[64:67], s47 offen lds
    s_add_u32 m0, s42, 21504
    s_add_u32 s47, s43, 762880
    buffer_load_dwordx4 v2, s[64:67], s47 offen lds
    s_add_u32 m0, s42, 22528
    s_add_u32 s47, s43, 768000
    buffer_load_dwordx4 v1, s[64:67], s47 offen lds
    s_add_u32 m0, s42, 23552
    s_add_u32 s47, s43, 773120
    buffer_load_dwordx4 v2, s[64:67], s47 offen lds
    s_waitcnt vmcnt(32)
    s_barrier
    s_add_u32 m0, s42, 98304
    s_add_u32 s47, s46, 20480
    buffer_load_dwordx4 v107, s[68:71], s47 offen sc1 lds
    s_add_u32 m0, s42, 100352
    s_add_u32 s47, s46, 53248
    buffer_load_dwordx4 v107, s[68:71], s47 offen sc1 lds
    s_add_u32 m0, s42, 102400
    s_add_u32 s47, s46, 86016
    buffer_load_dwordx4 v107, s[68:71], s47 offen sc1 lds
    s_add_u32 m0, s42, 104448
    s_add_u32 s47, s46, 118784
    buffer_load_dwordx4 v107, s[68:71], s47 offen sc1 lds
    s_add_u32 m0, s42, 99328
    s_add_u32 s47, s46, 21504
    buffer_load_dwordx4 v107, s[68:71], s47 offen sc1 lds
    s_add_u32 m0, s42, 101376
    s_add_u32 s47, s46, 54272
    buffer_load_dwordx4 v107, s[68:71], s47 offen sc1 lds
    s_add_u32 m0, s42, 103424
    s_add_u32 s47, s46, 87040
    buffer_load_dwordx4 v107, s[68:71], s47 offen sc1 lds
    s_add_u32 m0, s42, 105472
    s_add_u32 s47, s46, 119808
    buffer_load_dwordx4 v107, s[68:71], s47 offen sc1 lds
    s_add_u32 m0, s42, 32768
    s_add_u32 s47, s43, 819200
    buffer_load_dwordx4 v1, s[64:67], s47 offen lds
    s_add_u32 m0, s42, 33792
    s_add_u32 s47, s43, 824320
    buffer_load_dwordx4 v2, s[64:67], s47 offen lds
    s_add_u32 m0, s42, 34816
    s_add_u32 s47, s43, 829440
    buffer_load_dwordx4 v1, s[64:67], s47 offen lds
    s_add_u32 m0, s42, 35840
    s_add_u32 s47, s43, 834560
    buffer_load_dwordx4 v2, s[64:67], s47 offen lds
    s_add_u32 m0, s42, 36864
    s_add_u32 s47, s43, 839680
    buffer_load_dwordx4 v1, s[64:67], s47 offen lds
    s_add_u32 m0, s42, 37888
    s_add_u32 s47, s43, 844800
    buffer_load_dwordx4 v2, s[64:67], s47 offen lds
    s_add_u32 m0, s42, 38912
    s_add_u32 s47, s43, 849920
    buffer_load_dwordx4 v1, s[64:67], s47 offen lds
    s_add_u32 m0, s42, 39936
    s_add_u32 s47, s43, 855040
    buffer_load_dwordx4 v2, s[64:67], s47 offen lds
    s_waitcnt vmcnt(32)
    s_barrier
    s_add_u32 m0, s42, 114688
    s_add_u32 s47, s46, 22528
    buffer_load_dwordx4 v107, s[68:71], s47 offen sc1 lds
    s_add_u32 m0, s42, 116736
    s_add_u32 s47, s46, 55296
    buffer_load_dwordx4 v107, s[68:71], s47 offen sc1 lds
    s_add_u32 m0, s42, 118784
    s_add_u32 s47, s46, 88064
    buffer_load_dwordx4 v107, s[68:71], s47 offen sc1 lds
    s_add_u32 m0, s42, 120832
    s_add_u32 s47, s46, 120832
    buffer_load_dwordx4 v107, s[68:71], s47 offen sc1 lds
    s_add_u32 m0, s42, 115712
    s_add_u32 s47, s46, 23552
    buffer_load_dwordx4 v107, s[68:71], s47 offen sc1 lds
    s_add_u32 m0, s42, 117760
    s_add_u32 s47, s46, 56320
    buffer_load_dwordx4 v107, s[68:71], s47 offen sc1 lds
    s_add_u32 m0, s42, 119808
    s_add_u32 s47, s46, 89088
    buffer_load_dwordx4 v107, s[68:71], s47 offen sc1 lds
    s_add_u32 m0, s42, 121856
    s_add_u32 s47, s46, 121856
    buffer_load_dwordx4 v107, s[68:71], s47 offen sc1 lds
    s_add_u32 m0, s42, 49152
    s_add_u32 s47, s43, 901120
    buffer_load_dwordx4 v1, s[64:67], s47 offen lds
    s_add_u32 m0, s42, 50176
    s_add_u32 s47, s43, 906240
    buffer_load_dwordx4 v2, s[64:67], s47 offen lds
    s_add_u32 m0, s42, 51200
    s_add_u32 s47, s43, 911360
    buffer_load_dwordx4 v1, s[64:67], s47 offen lds
    s_add_u32 m0, s42, 52224
    s_add_u32 s47, s43, 916480
    buffer_load_dwordx4 v2, s[64:67], s47 offen lds
    s_add_u32 m0, s42, 53248
    s_add_u32 s47, s43, 921600
    buffer_load_dwordx4 v1, s[64:67], s47 offen lds
    s_add_u32 m0, s42, 54272
    s_add_u32 s47, s43, 926720
    buffer_load_dwordx4 v2, s[64:67], s47 offen lds
    s_add_u32 m0, s42, 55296
    s_add_u32 s47, s43, 931840
    buffer_load_dwordx4 v1, s[64:67], s47 offen lds
    s_add_u32 m0, s42, 56320
    s_add_u32 s47, s43, 936960
    buffer_load_dwordx4 v2, s[64:67], s47 offen lds
    s_waitcnt vmcnt(32)
    s_barrier
    s_add_u32 m0, s42, 65536
    s_add_u32 s47, s46, 24576
    buffer_load_dwordx4 v107, s[68:71], s47 offen sc1 lds
    s_add_u32 m0, s42, 67584
    s_add_u32 s47, s46, 57344
    buffer_load_dwordx4 v107, s[68:71], s47 offen sc1 lds
    s_add_u32 m0, s42, 69632
    s_add_u32 s47, s46, 90112
    buffer_load_dwordx4 v107, s[68:71], s47 offen sc1 lds
    s_add_u32 m0, s42, 71680
    s_add_u32 s47, s46, 122880
    buffer_load_dwordx4 v107, s[68:71], s47 offen sc1 lds
    s_add_u32 m0, s42, 66560
    s_add_u32 s47, s46, 25600
    buffer_load_dwordx4 v107, s[68:71], s47 offen sc1 lds
    s_add_u32 m0, s42, 68608
    s_add_u32 s47, s46, 58368
    buffer_load_dwordx4 v107, s[68:71], s47 offen sc1 lds
    s_add_u32 m0, s42, 70656
    s_add_u32 s47, s46, 91136
    buffer_load_dwordx4 v107, s[68:71], s47 offen sc1 lds
    s_add_u32 m0, s42, 72704
    s_add_u32 s47, s46, 123904
    buffer_load_dwordx4 v107, s[68:71], s47 offen sc1 lds
    s_add_u32 m0, s42, 0
    s_add_u32 s47, s43, 983040
    buffer_load_dwordx4 v1, s[64:67], s47 offen lds
    s_add_u32 m0, s42, 1024
    s_add_u32 s47, s43, 988160
    buffer_load_dwordx4 v2, s[64:67], s47 offen lds
    s_add_u32 m0, s42, 2048
    s_add_u32 s47, s43, 993280
    buffer_load_dwordx4 v1, s[64:67], s47 offen lds
    s_add_u32 m0, s42, 3072
    s_add_u32 s47, s43, 998400
    buffer_load_dwordx4 v2, s[64:67], s47 offen lds
    s_add_u32 m0, s42, 4096
    s_add_u32 s47, s43, 1003520
    buffer_load_dwordx4 v1, s[64:67], s47 offen lds
    s_add_u32 m0, s42, 5120
    s_add_u32 s47, s43, 1008640
    buffer_load_dwordx4 v2, s[64:67], s47 offen lds
    s_add_u32 m0, s42, 6144
    s_add_u32 s47, s43, 1013760
    buffer_load_dwordx4 v1, s[64:67], s47 offen lds
    s_add_u32 m0, s42, 7168
    s_add_u32 s47, s43, 1018880
    buffer_load_dwordx4 v2, s[64:67], s47 offen lds
    s_waitcnt vmcnt(32)
    s_barrier
    s_add_u32 m0, s42, 81920
    s_add_u32 s47, s46, 26624
    buffer_load_dwordx4 v107, s[68:71], s47 offen sc1 lds
    s_add_u32 m0, s42, 83968
    s_add_u32 s47, s46, 59392
    buffer_load_dwordx4 v107, s[68:71], s47 offen sc1 lds
    s_add_u32 m0, s42, 86016
    s_add_u32 s47, s46, 92160
    buffer_load_dwordx4 v107, s[68:71], s47 offen sc1 lds
    s_add_u32 m0, s42, 88064
    s_add_u32 s47, s46, 124928
    buffer_load_dwordx4 v107, s[68:71], s47 offen sc1 lds
    s_add_u32 m0, s42, 82944
    s_add_u32 s47, s46, 27648
    buffer_load_dwordx4 v107, s[68:71], s47 offen sc1 lds
    s_add_u32 m0, s42, 84992
    s_add_u32 s47, s46, 60416
    buffer_load_dwordx4 v107, s[68:71], s47 offen sc1 lds
    s_add_u32 m0, s42, 87040
    s_add_u32 s47, s46, 93184
    buffer_load_dwordx4 v107, s[68:71], s47 offen sc1 lds
    s_add_u32 m0, s42, 89088
    s_add_u32 s47, s46, 125952
    buffer_load_dwordx4 v107, s[68:71], s47 offen sc1 lds
    s_add_u32 m0, s42, 16384
    s_add_u32 s47, s43, 1064960
    buffer_load_dwordx4 v1, s[64:67], s47 offen lds
    s_add_u32 m0, s42, 17408
    s_add_u32 s47, s43, 1070080
    buffer_load_dwordx4 v2, s[64:67], s47 offen lds
    s_add_u32 m0, s42, 18432
    s_add_u32 s47, s43, 1075200
    buffer_load_dwordx4 v1, s[64:67], s47 offen lds
    s_add_u32 m0, s42, 19456
    s_add_u32 s47, s43, 1080320
    buffer_load_dwordx4 v2, s[64:67], s47 offen lds
    s_add_u32 m0, s42, 20480
    s_add_u32 s47, s43, 1085440
    buffer_load_dwordx4 v1, s[64:67], s47 offen lds
    s_add_u32 m0, s42, 21504
    s_add_u32 s47, s43, 1090560
    buffer_load_dwordx4 v2, s[64:67], s47 offen lds
    s_add_u32 m0, s42, 22528
    s_add_u32 s47, s43, 1095680
    buffer_load_dwordx4 v1, s[64:67], s47 offen lds
    s_add_u32 m0, s42, 23552
    s_add_u32 s47, s43, 1100800
    buffer_load_dwordx4 v2, s[64:67], s47 offen lds
    s_waitcnt vmcnt(32)
    s_barrier
    s_add_u32 m0, s42, 98304
    s_add_u32 s47, s46, 28672
    buffer_load_dwordx4 v107, s[68:71], s47 offen sc1 lds
    s_add_u32 m0, s42, 100352
    s_add_u32 s47, s46, 61440
    buffer_load_dwordx4 v107, s[68:71], s47 offen sc1 lds
    s_add_u32 m0, s42, 102400
    s_add_u32 s47, s46, 94208
    buffer_load_dwordx4 v107, s[68:71], s47 offen sc1 lds
    s_add_u32 m0, s42, 104448
    s_add_u32 s47, s46, 126976
    buffer_load_dwordx4 v107, s[68:71], s47 offen sc1 lds
    s_add_u32 m0, s42, 99328
    s_add_u32 s47, s46, 29696
    buffer_load_dwordx4 v107, s[68:71], s47 offen sc1 lds
    s_add_u32 m0, s42, 101376
    s_add_u32 s47, s46, 62464
    buffer_load_dwordx4 v107, s[68:71], s47 offen sc1 lds
    s_add_u32 m0, s42, 103424
    s_add_u32 s47, s46, 95232
    buffer_load_dwordx4 v107, s[68:71], s47 offen sc1 lds
    s_add_u32 m0, s42, 105472
    s_add_u32 s47, s46, 128000
    buffer_load_dwordx4 v107, s[68:71], s47 offen sc1 lds
    s_add_u32 m0, s42, 32768
    s_add_u32 s47, s43, 1146880
    buffer_load_dwordx4 v1, s[64:67], s47 offen lds
    s_add_u32 m0, s42, 33792
    s_add_u32 s47, s43, 1152000
    buffer_load_dwordx4 v2, s[64:67], s47 offen lds
    s_add_u32 m0, s42, 34816
    s_add_u32 s47, s43, 1157120
    buffer_load_dwordx4 v1, s[64:67], s47 offen lds
    s_add_u32 m0, s42, 35840
    s_add_u32 s47, s43, 1162240
    buffer_load_dwordx4 v2, s[64:67], s47 offen lds
    s_add_u32 m0, s42, 36864
    s_add_u32 s47, s43, 1167360
    buffer_load_dwordx4 v1, s[64:67], s47 offen lds
    s_add_u32 m0, s42, 37888
    s_add_u32 s47, s43, 1172480
    buffer_load_dwordx4 v2, s[64:67], s47 offen lds
    s_add_u32 m0, s42, 38912
    s_add_u32 s47, s43, 1177600
    buffer_load_dwordx4 v1, s[64:67], s47 offen lds
    s_add_u32 m0, s42, 39936
    s_add_u32 s47, s43, 1182720
    buffer_load_dwordx4 v2, s[64:67], s47 offen lds
    s_waitcnt vmcnt(32)
    s_barrier
    s_add_u32 m0, s42, 114688
    s_add_u32 s47, s46, 30720
    buffer_load_dwordx4 v107, s[68:71], s47 offen sc1 lds
    s_add_u32 m0, s42, 116736
    s_add_u32 s47, s46, 63488
    buffer_load_dwordx4 v107, s[68:71], s47 offen sc1 lds
    s_add_u32 m0, s42, 118784
    s_add_u32 s47, s46, 96256
    buffer_load_dwordx4 v107, s[68:71], s47 offen sc1 lds
    s_add_u32 m0, s42, 120832
    s_add_u32 s47, s46, 129024
    buffer_load_dwordx4 v107, s[68:71], s47 offen sc1 lds
    s_add_u32 m0, s42, 115712
    s_add_u32 s47, s46, 31744
    buffer_load_dwordx4 v107, s[68:71], s47 offen sc1 lds
    s_add_u32 m0, s42, 117760
    s_add_u32 s47, s46, 64512
    buffer_load_dwordx4 v107, s[68:71], s47 offen sc1 lds
    s_add_u32 m0, s42, 119808
    s_add_u32 s47, s46, 97280
    buffer_load_dwordx4 v107, s[68:71], s47 offen sc1 lds
    s_add_u32 m0, s42, 121856
    s_add_u32 s47, s46, 130048
    buffer_load_dwordx4 v107, s[68:71], s47 offen sc1 lds
    s_add_u32 m0, s42, 49152
    s_add_u32 s47, s43, 1228800
    buffer_load_dwordx4 v1, s[64:67], s47 offen lds
    s_add_u32 m0, s42, 50176
    s_add_u32 s47, s43, 1233920
    buffer_load_dwordx4 v2, s[64:67], s47 offen lds
    s_add_u32 m0, s42, 51200
    s_add_u32 s47, s43, 1239040
    buffer_load_dwordx4 v1, s[64:67], s47 offen lds
    s_add_u32 m0, s42, 52224
    s_add_u32 s47, s43, 1244160
    buffer_load_dwordx4 v2, s[64:67], s47 offen lds
    s_add_u32 m0, s42, 53248
    s_add_u32 s47, s43, 1249280
    buffer_load_dwordx4 v1, s[64:67], s47 offen lds
    s_add_u32 m0, s42, 54272
    s_add_u32 s47, s43, 1254400
    buffer_load_dwordx4 v2, s[64:67], s47 offen lds
    s_add_u32 m0, s42, 55296
    s_add_u32 s47, s43, 1259520
    buffer_load_dwordx4 v1, s[64:67], s47 offen lds
    s_add_u32 m0, s42, 56320
    s_add_u32 s47, s43, 1264640
    buffer_load_dwordx4 v2, s[64:67], s47 offen lds
    s_waitcnt vmcnt(32)
    s_barrier
    s_waitcnt vmcnt(16)
    s_barrier
    s_waitcnt vmcnt(0)
    s_barrier
    s_endpgm
L_kv:
    s_cmp_lg_u32 s2, 0
    s_cbranch_scc1 L_nonp
    s_cmp_lg_u32 s55, 6
    s_cbranch_scc1 L_nonp
    s_memrealtime s[96:97]
    s_waitcnt lgkmcnt(0)
    s_or_b32 s96, s96, 1
    v_mov_b32 v14, s96
    v_mov_b32 v15, s97
    v_mov_b32 v16, 0
    buffer_store_dwordx2 v[14:15], v16, s[84:87], 0 offen sc0 sc1
    s_waitcnt vmcnt(0)
    L_nonp:
    s_and_b32 s53, s38, 1
    s_mul_i32 s44, s53, 24576
    s_lshl_b32 s54, s53, 13
    s_mul_i32 s52, s53, 786432
    v_xor_b32 v112, v108, v109
    v_lshlrev_b32 v112, 4, v112
    v_lshlrev_b32 v113, 8, v109
    v_add_u32 v4, v112, v113
    v_xor_b32 v8, 64, v4
    v_xor_b32 v9, 128, v4
    v_xor_b32 v10, 192, v4
    v_lshlrev_b32 v112, 1, v109
    v_xor_b32 v112, v112, v108
    v_lshlrev_b32 v112, 4, v112
    v_add_u32 v5, v112, v113
    v_xor_b32 v6, 128, v5
    s_and_b32 s40, s3, 3
    s_mul_i32 s40, s40, 1310720
    s_add_u32 s88, s56, s40
    s_addc_u32 s89, s57, 0
    s_mov_b32 s90, 1310720
    s_mov_b32 s91, 0x00020000
    s_lshl_b32 s40, s4, 1
    s_add_u32 s40, s40, s53
    s_mul_i32 s51, s40, 5120
    v_min_u32 v12, 39, v0
    v_lshlrev_b32 v12, 7, v12
    s_getpc_b64 s[96:97]
    L_pc:
    s_sub_u32 s96, s96, L_pc-concat_heads__mha_block_cached__gqa_block_cached__near_ridge_kernel
    s_subb_u32 s97, s97, 0
    s_mov_b32 s64, s96
    s_mov_b32 s65, s97
    s_mov_b32 s66, L_end-concat_heads__mha_block_cached__gqa_block_cached__near_ridge_kernel
    s_mov_b32 s67, 0x00020000
    s_lshl_b32 s40, s4, 1
    s_add_u32 s40, s40, s53
    s_mul_i32 s40, s40, 768
    v_min_u32 v17, 5, v0
    v_lshlrev_b32 v17, 7, v17
    buffer_load_dword v13, v17, s[64:67], s40 offen
    s_barrier
    s_barrier
    s_barrier
    s_barrier
    s_add_u32 m0, s44, 0
    s_add_u32 s49, s52, 0
    buffer_load_dwordx4 v4, s[16:19], s49 offen offset:0 lds
    s_add_u32 m0, s44, 12288
    s_add_u32 s49, s52, 393216
    buffer_load_dwordx4 v4, s[16:19], s49 offen offset:0 lds
    s_add_u32 m0, s44, 0
    s_add_u32 s49, s52, 0
    buffer_load_dwordx4 v8, s[16:19], s49 offen offset:1024 lds
    s_add_u32 m0, s44, 12288
    s_add_u32 s49, s52, 393216
    buffer_load_dwordx4 v8, s[16:19], s49 offen offset:1024 lds
    s_add_u32 m0, s44, 0
    s_add_u32 s49, s52, 0
    buffer_load_dwordx4 v9, s[16:19], s49 offen offset:2048 lds
    s_add_u32 m0, s44, 12288
    s_add_u32 s49, s52, 393216
    buffer_load_dwordx4 v9, s[16:19], s49 offen offset:2048 lds
    s_barrier
    s_add_u32 m0, s44, 0
    s_add_u32 s49, s52, 0
    buffer_load_dwordx4 v10, s[16:19], s49 offen offset:3072 lds
    s_add_u32 m0, s44, 12288
    s_add_u32 s49, s52, 393216
    buffer_load_dwordx4 v10, s[16:19], s49 offen offset:3072 lds
    s_add_u32 m0, s44, 4096
    s_add_u32 s49, s52, 4096
    buffer_load_dwordx4 v4, s[16:19], s49 offen offset:0 lds
    s_add_u32 m0, s44, 16384
    s_add_u32 s49, s52, 397312
    buffer_load_dwordx4 v4, s[16:19], s49 offen offset:0 lds
    s_add_u32 m0, s44, 4096
    s_add_u32 s49, s52, 4096
    buffer_load_dwordx4 v8, s[16:19], s49 offen offset:1024 lds
    s_add_u32 m0, s44, 16384
    s_add_u32 s49, s52, 397312
    buffer_load_dwordx4 v8, s[16:19], s49 offen offset:1024 lds
    s_barrier
    s_add_u32 m0, s44, 4096
    s_add_u32 s49, s52, 4096
    buffer_load_dwordx4 v9, s[16:19], s49 offen offset:2048 lds
    s_add_u32 m0, s44, 16384
    s_add_u32 s49, s52, 397312
    buffer_load_dwordx4 v9, s[16:19], s49 offen offset:2048 lds
    s_add_u32 m0, s44, 4096
    s_add_u32 s49, s52, 4096
    buffer_load_dwordx4 v10, s[16:19], s49 offen offset:3072 lds
    s_add_u32 m0, s44, 16384
    s_add_u32 s49, s52, 397312
    buffer_load_dwordx4 v10, s[16:19], s49 offen offset:3072 lds
    s_add_u32 m0, s44, 8192
    s_add_u32 s49, s52, 8192
    buffer_load_dwordx4 v4, s[16:19], s49 offen offset:0 lds
    s_add_u32 m0, s44, 20480
    s_add_u32 s49, s52, 401408
    buffer_load_dwordx4 v4, s[16:19], s49 offen offset:0 lds
    s_barrier
    s_add_u32 m0, s44, 8192
    s_add_u32 s49, s52, 8192
    buffer_load_dwordx4 v8, s[16:19], s49 offen offset:1024 lds
    s_add_u32 m0, s44, 20480
    s_add_u32 s49, s52, 401408
    buffer_load_dwordx4 v8, s[16:19], s49 offen offset:1024 lds
    s_add_u32 m0, s44, 8192
    s_add_u32 s49, s52, 8192
    buffer_load_dwordx4 v9, s[16:19], s49 offen offset:2048 lds
    s_add_u32 m0, s44, 20480
    s_add_u32 s49, s52, 401408
    buffer_load_dwordx4 v9, s[16:19], s49 offen offset:2048 lds
    s_add_u32 m0, s44, 8192
    s_add_u32 s49, s52, 8192
    buffer_load_dwordx4 v10, s[16:19], s49 offen offset:3072 lds
    s_add_u32 m0, s44, 20480
    s_add_u32 s49, s52, 401408
    buffer_load_dwordx4 v10, s[16:19], s49 offen offset:3072 lds
    s_barrier
    s_barrier
    s_barrier
    s_barrier
    s_barrier
    s_barrier
    s_barrier
    s_barrier
    s_barrier
    s_barrier
    s_add_u32 m0, s54, 73728
    s_add_u32 s49, s52, 0
    buffer_load_dwordx4 v5, s[20:23], s49 offen offset:0 lds
    s_add_u32 m0, s54, 73728
    s_add_u32 s49, s52, 0
    buffer_load_dwordx4 v6, s[20:23], s49 offen offset:1024 lds
    s_add_u32 m0, s54, 73728
    s_add_u32 s49, s52, 0
    buffer_load_dwordx4 v5, s[20:23], s49 offen offset:2048 lds
    s_add_u32 m0, s54, 73728
    s_add_u32 s49, s52, 0
    buffer_load_dwordx4 v6, s[20:23], s49 offen offset:3072 lds
    s_add_u32 m0, s54, 77824
    s_add_u32 s49, s52, 393216
    buffer_load_dwordx4 v5, s[20:23], s49 offen offset:0 lds
    s_add_u32 m0, s54, 77824
    s_add_u32 s49, s52, 393216
    buffer_load_dwordx4 v6, s[20:23], s49 offen offset:1024 lds
    s_add_u32 m0, s54, 77824
    s_add_u32 s49, s52, 393216
    buffer_load_dwordx4 v5, s[20:23], s49 offen offset:2048 lds
    s_add_u32 m0, s54, 77824
    s_add_u32 s49, s52, 393216
    buffer_load_dwordx4 v6, s[20:23], s49 offen offset:3072 lds
    s_barrier
    s_add_u32 m0, s54, 122880
    s_add_u32 s49, s52, 8192
    buffer_load_dwordx4 v5, s[20:23], s49 offen offset:0 lds
    s_add_u32 m0, s54, 122880
    s_add_u32 s49, s52, 8192
    buffer_load_dwordx4 v6, s[20:23], s49 offen offset:1024 lds
    s_add_u32 m0, s54, 122880
    s_add_u32 s49, s52, 8192
    buffer_load_dwordx4 v5, s[20:23], s49 offen offset:2048 lds
    s_add_u32 m0, s54, 122880
    s_add_u32 s49, s52, 8192
    buffer_load_dwordx4 v6, s[20:23], s49 offen offset:3072 lds
    s_add_u32 m0, s54, 126976
    s_add_u32 s49, s52, 401408
    buffer_load_dwordx4 v5, s[20:23], s49 offen offset:0 lds
    s_add_u32 m0, s54, 126976
    s_add_u32 s49, s52, 401408
    buffer_load_dwordx4 v6, s[20:23], s49 offen offset:1024 lds
    s_add_u32 m0, s54, 126976
    s_add_u32 s49, s52, 401408
    buffer_load_dwordx4 v5, s[20:23], s49 offen offset:2048 lds
    s_add_u32 m0, s54, 126976
    s_add_u32 s49, s52, 401408
    buffer_load_dwordx4 v6, s[20:23], s49 offen offset:3072 lds
    s_barrier
    s_waitcnt vmcnt(16)
    s_barrier
    s_add_u32 m0, s54, 98304
    s_add_u32 s49, s52, 4096
    buffer_load_dwordx4 v5, s[20:23], s49 offen offset:0 lds
    s_add_u32 m0, s54, 98304
    s_add_u32 s49, s52, 4096
    buffer_load_dwordx4 v6, s[20:23], s49 offen offset:1024 lds
    s_add_u32 m0, s54, 98304
    s_add_u32 s49, s52, 4096
    buffer_load_dwordx4 v5, s[20:23], s49 offen offset:2048 lds
    s_add_u32 m0, s54, 98304
    s_add_u32 s49, s52, 4096
    buffer_load_dwordx4 v6, s[20:23], s49 offen offset:3072 lds
    s_add_u32 m0, s54, 102400
    s_add_u32 s49, s52, 397312
    buffer_load_dwordx4 v5, s[20:23], s49 offen offset:0 lds
    s_add_u32 m0, s54, 102400
    s_add_u32 s49, s52, 397312
    buffer_load_dwordx4 v6, s[20:23], s49 offen offset:1024 lds
    s_add_u32 m0, s54, 102400
    s_add_u32 s49, s52, 397312
    buffer_load_dwordx4 v5, s[20:23], s49 offen offset:2048 lds
    s_add_u32 m0, s54, 102400
    s_add_u32 s49, s52, 397312
    buffer_load_dwordx4 v6, s[20:23], s49 offen offset:3072 lds
    s_add_u32 s49, s51, 0
    buffer_load_dword v13, v12, s[88:91], s49 offen
    s_add_u32 s49, s51, 327680
    buffer_load_dword v13, v12, s[88:91], s49 offen
    s_waitcnt vmcnt(2)
    s_barrier
    v_mov_b32 v112, 0
    s_mov_b32 s45, 0
    L_nonce_kv:
    buffer_load_dwordx2 v[116:117], v112, s[84:87], 0 offen sc0 sc1
    s_add_u32 s45, s45, 1
    s_waitcnt vmcnt(0)
    v_readfirstlane_b32 s44, v116
    s_cmp_ge_u32 s45, 0x100000
    s_cbranch_scc1 L_nonce_kv_d
    s_cmp_eq_u32 s44, 0
    s_cbranch_scc1 L_nonce_kv
    L_nonce_kv_d:
    s_mul_i32 s60, s4, 52
    s_lshr_b32 s60, s60, 8
    s_mul_i32 s61, s60, 5
    s_sub_u32 s61, s4, s61
    s_and_b32 s62, s3, 3
    s_add_u32 s76, s36, 15728640
    s_addc_u32 s77, s37, 0
    s_mov_b32 s78, 0x20000
    s_mov_b32 s79, 0x00020000
    s_barrier
    s_cmp_eq_u32 s55, 6
    s_cbranch_scc1 L_pub
    s_add_u32 s49, s51, 655360
    buffer_load_dword v13, v12, s[88:91], s49 offen
    s_sub_u32 s49, s49, 5120
    buffer_load_dword v13, v12, s[88:91], s49 offen
    s_add_u32 s49, s51, 983040
    buffer_load_dword v13, v12, s[88:91], s49 offen
    s_sub_u32 s49, s49, 5120
    buffer_load_dword v13, v12, s[88:91], s49 offen
    s_endpgm
    L_pub:
    s_lshl_b32 s40, s3, 13
    s_lshl_b32 s41, s4, 3
    v_lshlrev_b32 v8, 8, v0
    v_add_u32 v8, s41, v8
    s_mov_b32 exec_hi, 0
    buffer_store_dwordx2 v[116:117], v8, s[76:79], s40 offen sc0 sc1
    s_cmp_ge_u32 s4, 30
    s_cbranch_scc1 L_done
    s_lshl_b32 s41, s4, 8
    s_add_u32 s40, s40, s41
    v_lshlrev_b32 v9, 3, v0
    s_mul_i32 s41, s60, 43
    s_lshr_b32 s41, s41, 6
    s_lshl_b32 s42, s60, 1
    s_add_u32 s42, s42, 1
    s_mul_i32 s42, s42, 43
    s_lshr_b32 s42, s42, 7
    s_lshl_b32 s41, 1, s41
    s_lshl_b32 s42, 1, s42
    s_or_b32 s50, s41, s42
    s_mov_b32 s51, 0
    s_mov_b32 s45, 0
    s_mov_b32 s54, 0x11111111
    s_not_b32 s49, s50
    s_and_b32 s49, s49, 15
    s_mul_i32 s49, s49, 0x11111111
    v_mov_b32 v10, 163776
    L_pick_0:
    s_or_b32 s52, s51, s49
    s_lshr_b32 s53, s52, 1
    s_and_b32 s52, s52, s53
    s_lshr_b32 s53, s52, 2
    s_and_b32 s52, s52, s53
    s_and_b32 s52, s52, 1
    s_cbranch_scc1 L_pick_0_d
    buffer_load_dwordx2 v[4:5], v9, s[76:79], s40 offen sc0 sc1
    s_add_u32 s45, s45, 1
    s_waitcnt vmcnt(0)
    v_cmp_eq_u64 vcc, v[4:5], v[116:117]
    s_mov_b32 s51, vcc_lo
    s_cmp_lt_u32 s45, 0x100000
    s_cbranch_scc1 L_pick_0
    s_mov_b32 s51, -1
    s_branch L_pick_0
    L_pick_0_d:
    s_barrier
    L_pick_1:
    s_or_b32 s52, s51, s49
    s_lshr_b32 s53, s52, 1
    s_and_b32 s52, s52, s53
    s_lshr_b32 s53, s52, 2
    s_and_b32 s52, s52, s53
    s_and_b32 s52, s52, 16
    s_cbranch_scc1 L_pick_1_d
    buffer_load_dwordx2 v[4:5], v9, s[76:79], s40 offen sc0 sc1
    s_add_u32 s45, s45, 1
    s_waitcnt vmcnt(0)
    v_cmp_eq_u64 vcc, v[4:5], v[116:117]
    s_mov_b32 s51, vcc_lo
    s_cmp_lt_u32 s45, 0x100000
    s_cbranch_scc1 L_pick_1
    s_mov_b32 s51, -1
    s_branch L_pick_1
    L_pick_1_d:
    s_barrier
    s_barrier
    L_pick_2:
    s_or_b32 s52, s51, s49
    s_lshr_b32 s53, s52, 1
    s_and_b32 s52, s52, s53
    s_lshr_b32 s53, s52, 2
    s_and_b32 s52, s52, s53
    s_and_b32 s52, s52, 256
    s_cbranch_scc1 L_pick_2_d
    buffer_load_dwordx2 v[4:5], v9, s[76:79], s40 offen sc0 sc1
    s_add_u32 s45, s45, 1
    s_waitcnt vmcnt(0)
    v_cmp_eq_u64 vcc, v[4:5], v[116:117]
    s_mov_b32 s51, vcc_lo
    s_cmp_lt_u32 s45, 0x100000
    s_cbranch_scc1 L_pick_2
    s_mov_b32 s51, -1
    s_branch L_pick_2
    L_pick_2_d:
    s_barrier
    s_barrier
    L_pick_3:
    s_or_b32 s52, s51, s49
    s_lshr_b32 s53, s52, 1
    s_and_b32 s52, s52, s53
    s_lshr_b32 s53, s52, 2
    s_and_b32 s52, s52, s53
    s_and_b32 s52, s52, 4096
    s_cbranch_scc1 L_pick_3_d
    buffer_load_dwordx2 v[4:5], v9, s[76:79], s40 offen sc0 sc1
    s_add_u32 s45, s45, 1
    s_waitcnt vmcnt(0)
    v_cmp_eq_u64 vcc, v[4:5], v[116:117]
    s_mov_b32 s51, vcc_lo
    s_cmp_lt_u32 s45, 0x100000
    s_cbranch_scc1 L_pick_3
    s_mov_b32 s51, -1
    s_branch L_pick_3
    L_pick_3_d:
    s_barrier
    s_barrier
    L_pick_4:
    s_or_b32 s52, s51, s49
    s_lshr_b32 s53, s52, 1
    s_and_b32 s52, s52, s53
    s_lshr_b32 s53, s52, 2
    s_and_b32 s52, s52, s53
    s_and_b32 s52, s52, 65536
    s_cbranch_scc1 L_pick_4_d
    buffer_load_dwordx2 v[4:5], v9, s[76:79], s40 offen sc0 sc1
    s_add_u32 s45, s45, 1
    s_waitcnt vmcnt(0)
    v_cmp_eq_u64 vcc, v[4:5], v[116:117]
    s_mov_b32 s51, vcc_lo
    s_cmp_lt_u32 s45, 0x100000
    s_cbranch_scc1 L_pick_4
    s_mov_b32 s51, -1
    s_branch L_pick_4
    L_pick_4_d:
    s_barrier
    s_barrier
    L_pick_5:
    s_or_b32 s52, s51, s49
    s_lshr_b32 s53, s52, 1
    s_and_b32 s52, s52, s53
    s_lshr_b32 s53, s52, 2
    s_and_b32 s52, s52, s53
    s_and_b32 s52, s52, 1048576
    s_cbranch_scc1 L_pick_5_d
    buffer_load_dwordx2 v[4:5], v9, s[76:79], s40 offen sc0 sc1
    s_add_u32 s45, s45, 1
    s_waitcnt vmcnt(0)
    v_cmp_eq_u64 vcc, v[4:5], v[116:117]
    s_mov_b32 s51, vcc_lo
    s_cmp_lt_u32 s45, 0x100000
    s_cbranch_scc1 L_pick_5
    s_mov_b32 s51, -1
    s_branch L_pick_5
    L_pick_5_d:
    s_barrier
    s_barrier
    L_pick_6:
    s_or_b32 s52, s51, s49
    s_lshr_b32 s53, s52, 1
    s_and_b32 s52, s52, s53
    s_lshr_b32 s53, s52, 2
    s_and_b32 s52, s52, s53
    s_and_b32 s52, s52, 16777216
    s_cbranch_scc1 L_pick_6_d
    buffer_load_dwordx2 v[4:5], v9, s[76:79], s40 offen sc0 sc1
    s_add_u32 s45, s45, 1
    s_waitcnt vmcnt(0)
    v_cmp_eq_u64 vcc, v[4:5], v[116:117]
    s_mov_b32 s51, vcc_lo
    s_cmp_lt_u32 s45, 0x100000
    s_cbranch_scc1 L_pick_6
    s_mov_b32 s51, -1
    s_branch L_pick_6
    L_pick_6_d:
    s_barrier
    s_barrier
    L_pick_7:
    s_or_b32 s52, s51, s49
    s_lshr_b32 s53, s52, 1
    s_and_b32 s52, s52, s53
    s_lshr_b32 s53, s52, 2
    s_and_b32 s52, s52, s53
    s_and_b32 s52, s52, 268435456
    s_cbranch_scc1 L_pick_7_d
    buffer_load_dwordx2 v[4:5], v9, s[76:79], s40 offen sc0 sc1
    s_add_u32 s45, s45, 1
    s_waitcnt vmcnt(0)
    v_cmp_eq_u64 vcc, v[4:5], v[116:117]
    s_mov_b32 s51, vcc_lo
    s_cmp_lt_u32 s45, 0x100000
    s_cbranch_scc1 L_pick_7
    s_mov_b32 s51, -1
    s_branch L_pick_7
    L_pick_7_d:
    s_barrier
    s_barrier
    s_barrier
    s_barrier
    s_barrier
    s_endpgm
L_compute:
    s_mul_i32 s43, s38, 6144
    s_mul_i32 s44, s38, 12288
    s_lshl_b32 s54, s38, 12
    s_add_u32 s41, s39, s38
    s_mul_i32 s40, s3, 48
    s_mul_i32 s41, s41, 3
    s_add_u32 s40, s40, s41
    s_lshl_b32 s40, s40, 5
    s_and_b32 s41, s7, 7
    s_lshl_b32 s41, s41, 2
    s_add_u32 s40, s40, s41
    s_lshl_b32 s40, s40, 10
    s_add_u32 s24, s36, s40
    s_addc_u32 s25, s37, 0
    s_sub_u32 s26, 12582912, s40
    s_mov_b32 s27, 0x00020000
    s_mov_b32 s47, 32768
    s_mov_b32 s48, 65536
    v_lshrrev_b32 v112, 1, v108
    v_xor_b32 v112, v112, v109
    v_lshlrev_b32 v112, 4, v112
    v_lshlrev_b32 v113, 7, v108
    v_add_u32 v112, v112, v113
    s_add_u32 s40, s43, 49152
    v_add_u32 v104, s40, v112
    v_xor_b32 v105, 64, v104
    v_xor_b32 v112, v108, v109
    v_lshlrev_b32 v112, 4, v112
    v_lshlrev_b32 v113, 8, v108
    v_add_u32 v112, v112, v113
    v_add_u32 v106, s44, v112
    v_lshlrev_b32 v112, 3, v109
    v_add_u32 v112, v112, v110
    v_lshlrev_b32 v112, 8, v112
    v_and_b32 v113, 1, v110
    v_xor_b32 v113, v113, v111
    v_lshlrev_b32 v113, 4, v113
    v_add_u32 v112, v112, v113
    v_and_b32 v113, 1, v111
    v_lshlrev_b32 v113, 3, v113
    v_add_u32 v112, v112, v113
    v_add_u32 v112, 122880, v112
    v_and_b32 v113, 1, v109
    v_lshlrev_b32 v113, 1, v113
    v_lshrrev_b32 v114, 1, v110
    v_or_b32 v113, v113, v114
    v_xor_b32 v114, 0, v113
    v_lshlrev_b32 v114, 6, v114
    v_add_u32 v96, v112, v114
    v_xor_b32 v97, 8, v96
    v_xor_b32 v114, 1, v113
    v_lshlrev_b32 v114, 6, v114
    v_add_u32 v98, v112, v114
    v_xor_b32 v99, 8, v98
    v_xor_b32 v114, 2, v113
    v_lshlrev_b32 v114, 6, v114
    v_add_u32 v100, v112, v114
    v_xor_b32 v101, 8, v100
    v_xor_b32 v114, 3, v113
    v_lshlrev_b32 v114, 6, v114
    v_add_u32 v102, v112, v114
    v_xor_b32 v103, 8, v102
    s_mul_i32 s60, s4, 52
    s_lshr_b32 s60, s60, 8
    s_mul_i32 s61, s60, 5
    s_sub_u32 s61, s4, s61
    s_and_b32 s62, s3, 3
    s_add_u32 s76, s36, 15728640
    s_addc_u32 s77, s37, 0
    s_mov_b32 s78, 0x20000
    s_mov_b32 s79, 0x00020000
    s_barrier
    ds_read_b128 a[64:67], v104 offset:0
    ds_read_b128 a[68:71], v104 offset:2048
    ds_read_b128 a[72:75], v104 offset:4096
    ds_read_b64_tr_b16 a[0:1], v96 offset:0
    ds_read_b64_tr_b16 a[2:3], v96 offset:1024
    ds_read_b64_tr_b16 a[4:5], v97 offset:0
    ds_read_b64_tr_b16 a[6:7], v97 offset:1024
    ds_read_b64_tr_b16 a[8:9], v98 offset:0
    ds_read_b64_tr_b16 a[10:11], v98 offset:1024
    ds_read_b64_tr_b16 a[12:13], v99 offset:0
    ds_read_b64_tr_b16 a[14:15], v99 offset:1024
    ds_read_b64_tr_b16 a[16:17], v100 offset:0
    ds_read_b64_tr_b16 a[18:19], v100 offset:1024
    ds_read_b64_tr_b16 a[20:21], v101 offset:0
    ds_read_b64_tr_b16 a[22:23], v101 offset:1024
    ds_read_b64_tr_b16 a[24:25], v102 offset:0
    ds_read_b64_tr_b16 a[26:27], v102 offset:1024
    ds_read_b64_tr_b16 a[28:29], v103 offset:0
    ds_read_b64_tr_b16 a[30:31], v103 offset:1024
    s_waitcnt lgkmcnt(0)
    s_barrier
    v_mfma_f32_16x16x32_bf16 v[0:3], a[0:3], a[64:67], 0
    ds_read_b128 a[76:79], v105 offset:0
    v_mfma_f32_16x16x32_bf16 v[4:7], a[0:3], a[68:71], 0
    ds_read_b128 a[80:83], v105 offset:2048
    v_mfma_f32_16x16x32_bf16 v[8:11], a[0:3], a[72:75], 0
    ds_read_b128 a[84:87], v105 offset:4096
    v_mfma_f32_16x16x32_bf16 v[12:15], a[4:7], a[64:67], 0
    ds_read_b64_tr_b16 a[32:33], v96 offset:8192
    v_mfma_f32_16x16x32_bf16 v[16:19], a[4:7], a[68:71], 0
    ds_read_b64_tr_b16 a[34:35], v96 offset:9216
    v_mfma_f32_16x16x32_bf16 v[20:23], a[4:7], a[72:75], 0
    ds_read_b64_tr_b16 a[36:37], v97 offset:8192
    v_mfma_f32_16x16x32_bf16 v[24:27], a[8:11], a[64:67], 0
    ds_read_b64_tr_b16 a[38:39], v97 offset:9216
    v_mfma_f32_16x16x32_bf16 v[28:31], a[8:11], a[68:71], 0
    ds_read_b64_tr_b16 a[40:41], v98 offset:8192
    v_mfma_f32_16x16x32_bf16 v[32:35], a[8:11], a[72:75], 0
    ds_read_b64_tr_b16 a[42:43], v98 offset:9216
    v_mfma_f32_16x16x32_bf16 v[36:39], a[12:15], a[64:67], 0
    ds_read_b64_tr_b16 a[44:45], v99 offset:8192
    v_mfma_f32_16x16x32_bf16 v[40:43], a[12:15], a[68:71], 0
    ds_read_b64_tr_b16 a[46:47], v99 offset:9216
    v_mfma_f32_16x16x32_bf16 v[44:47], a[12:15], a[72:75], 0
    ds_read_b64_tr_b16 a[48:49], v100 offset:8192
    v_mfma_f32_16x16x32_bf16 v[48:51], a[16:19], a[64:67], 0
    ds_read_b64_tr_b16 a[50:51], v100 offset:9216
    v_mfma_f32_16x16x32_bf16 v[52:55], a[16:19], a[68:71], 0
    ds_read_b64_tr_b16 a[52:53], v101 offset:8192
    v_mfma_f32_16x16x32_bf16 v[56:59], a[16:19], a[72:75], 0
    ds_read_b64_tr_b16 a[54:55], v101 offset:9216
    v_mfma_f32_16x16x32_bf16 v[60:63], a[20:23], a[64:67], 0
    ds_read_b64_tr_b16 a[56:57], v102 offset:8192
    v_mfma_f32_16x16x32_bf16 v[64:67], a[20:23], a[68:71], 0
    ds_read_b64_tr_b16 a[58:59], v102 offset:9216
    v_mfma_f32_16x16x32_bf16 v[68:71], a[20:23], a[72:75], 0
    ds_read_b64_tr_b16 a[60:61], v103 offset:8192
    v_mfma_f32_16x16x32_bf16 v[72:75], a[24:27], a[64:67], 0
    ds_read_b64_tr_b16 a[62:63], v103 offset:9216
    v_mfma_f32_16x16x32_bf16 v[76:79], a[24:27], a[68:71], 0
    v_mfma_f32_16x16x32_bf16 v[80:83], a[24:27], a[72:75], 0
    v_mfma_f32_16x16x32_bf16 v[84:87], a[28:31], a[64:67], 0
    v_mfma_f32_16x16x32_bf16 v[88:91], a[28:31], a[68:71], 0
    v_mfma_f32_16x16x32_bf16 v[92:95], a[28:31], a[72:75], 0
    s_waitcnt lgkmcnt(0)
    s_barrier
    v_mfma_f32_16x16x32_bf16 v[0:3], a[32:35], a[76:79], v[0:3]
    ds_read_b128 a[64:67], v104 offset:24576
    v_mfma_f32_16x16x32_bf16 v[4:7], a[32:35], a[80:83], v[4:7]
    ds_read_b128 a[68:71], v104 offset:26624
    v_mfma_f32_16x16x32_bf16 v[8:11], a[32:35], a[84:87], v[8:11]
    ds_read_b128 a[72:75], v104 offset:28672
    v_mfma_f32_16x16x32_bf16 v[12:15], a[36:39], a[76:79], v[12:15]
    ds_read_b64_tr_b16 a[0:1], v96 offset:16384
    v_mfma_f32_16x16x32_bf16 v[16:19], a[36:39], a[80:83], v[16:19]
    ds_read_b64_tr_b16 a[2:3], v96 offset:17408
    v_mfma_f32_16x16x32_bf16 v[20:23], a[36:39], a[84:87], v[20:23]
    ds_read_b64_tr_b16 a[4:5], v97 offset:16384
    v_mfma_f32_16x16x32_bf16 v[24:27], a[40:43], a[76:79], v[24:27]
    ds_read_b64_tr_b16 a[6:7], v97 offset:17408
    v_mfma_f32_16x16x32_bf16 v[28:31], a[40:43], a[80:83], v[28:31]
    ds_read_b64_tr_b16 a[8:9], v98 offset:16384
    v_mfma_f32_16x16x32_bf16 v[32:35], a[40:43], a[84:87], v[32:35]
    ds_read_b64_tr_b16 a[10:11], v98 offset:17408
    v_mfma_f32_16x16x32_bf16 v[36:39], a[44:47], a[76:79], v[36:39]
    ds_read_b64_tr_b16 a[12:13], v99 offset:16384
    v_mfma_f32_16x16x32_bf16 v[40:43], a[44:47], a[80:83], v[40:43]
    ds_read_b64_tr_b16 a[14:15], v99 offset:17408
    v_mfma_f32_16x16x32_bf16 v[44:47], a[44:47], a[84:87], v[44:47]
    ds_read_b64_tr_b16 a[16:17], v100 offset:16384
    v_mfma_f32_16x16x32_bf16 v[48:51], a[48:51], a[76:79], v[48:51]
    ds_read_b64_tr_b16 a[18:19], v100 offset:17408
    v_mfma_f32_16x16x32_bf16 v[52:55], a[48:51], a[80:83], v[52:55]
    ds_read_b64_tr_b16 a[20:21], v101 offset:16384
    v_mfma_f32_16x16x32_bf16 v[56:59], a[48:51], a[84:87], v[56:59]
    ds_read_b64_tr_b16 a[22:23], v101 offset:17408
    v_mfma_f32_16x16x32_bf16 v[60:63], a[52:55], a[76:79], v[60:63]
    ds_read_b64_tr_b16 a[24:25], v102 offset:16384
    v_mfma_f32_16x16x32_bf16 v[64:67], a[52:55], a[80:83], v[64:67]
    ds_read_b64_tr_b16 a[26:27], v102 offset:17408
    v_mfma_f32_16x16x32_bf16 v[68:71], a[52:55], a[84:87], v[68:71]
    ds_read_b64_tr_b16 a[28:29], v103 offset:16384
    v_mfma_f32_16x16x32_bf16 v[72:75], a[56:59], a[76:79], v[72:75]
    ds_read_b64_tr_b16 a[30:31], v103 offset:17408
    v_mfma_f32_16x16x32_bf16 v[76:79], a[56:59], a[80:83], v[76:79]
    v_mfma_f32_16x16x32_bf16 v[80:83], a[56:59], a[84:87], v[80:83]
    v_mfma_f32_16x16x32_bf16 v[84:87], a[60:63], a[76:79], v[84:87]
    v_mfma_f32_16x16x32_bf16 v[88:91], a[60:63], a[80:83], v[88:91]
    v_mfma_f32_16x16x32_bf16 v[92:95], a[60:63], a[84:87], v[92:95]
    s_waitcnt lgkmcnt(0)
    s_barrier
    v_mfma_f32_16x16x32_bf16 v[0:3], a[0:3], a[64:67], v[0:3]
    ds_read_b128 a[76:79], v105 offset:24576
    v_mfma_f32_16x16x32_bf16 v[4:7], a[0:3], a[68:71], v[4:7]
    ds_read_b128 a[80:83], v105 offset:26624
    v_mfma_f32_16x16x32_bf16 v[8:11], a[0:3], a[72:75], v[8:11]
    ds_read_b128 a[84:87], v105 offset:28672
    v_mfma_f32_16x16x32_bf16 v[12:15], a[4:7], a[64:67], v[12:15]
    ds_read_b64_tr_b16 a[32:33], v96 offset:24576
    v_mfma_f32_16x16x32_bf16 v[16:19], a[4:7], a[68:71], v[16:19]
    ds_read_b64_tr_b16 a[34:35], v96 offset:25600
    v_mfma_f32_16x16x32_bf16 v[20:23], a[4:7], a[72:75], v[20:23]
    ds_read_b64_tr_b16 a[36:37], v97 offset:24576
    v_mfma_f32_16x16x32_bf16 v[24:27], a[8:11], a[64:67], v[24:27]
    ds_read_b64_tr_b16 a[38:39], v97 offset:25600
    v_mfma_f32_16x16x32_bf16 v[28:31], a[8:11], a[68:71], v[28:31]
    ds_read_b64_tr_b16 a[40:41], v98 offset:24576
    v_mfma_f32_16x16x32_bf16 v[32:35], a[8:11], a[72:75], v[32:35]
    ds_read_b64_tr_b16 a[42:43], v98 offset:25600
    v_mfma_f32_16x16x32_bf16 v[36:39], a[12:15], a[64:67], v[36:39]
    ds_read_b64_tr_b16 a[44:45], v99 offset:24576
    v_mfma_f32_16x16x32_bf16 v[40:43], a[12:15], a[68:71], v[40:43]
    ds_read_b64_tr_b16 a[46:47], v99 offset:25600
    v_mfma_f32_16x16x32_bf16 v[44:47], a[12:15], a[72:75], v[44:47]
    ds_read_b64_tr_b16 a[48:49], v100 offset:24576
    v_mfma_f32_16x16x32_bf16 v[48:51], a[16:19], a[64:67], v[48:51]
    ds_read_b64_tr_b16 a[50:51], v100 offset:25600
    v_mfma_f32_16x16x32_bf16 v[52:55], a[16:19], a[68:71], v[52:55]
    ds_read_b64_tr_b16 a[52:53], v101 offset:24576
    v_mfma_f32_16x16x32_bf16 v[56:59], a[16:19], a[72:75], v[56:59]
    ds_read_b64_tr_b16 a[54:55], v101 offset:25600
    v_mfma_f32_16x16x32_bf16 v[60:63], a[20:23], a[64:67], v[60:63]
    ds_read_b64_tr_b16 a[56:57], v102 offset:24576
    v_mfma_f32_16x16x32_bf16 v[64:67], a[20:23], a[68:71], v[64:67]
    ds_read_b64_tr_b16 a[58:59], v102 offset:25600
    v_mfma_f32_16x16x32_bf16 v[68:71], a[20:23], a[72:75], v[68:71]
    ds_read_b64_tr_b16 a[60:61], v103 offset:24576
    v_mfma_f32_16x16x32_bf16 v[72:75], a[24:27], a[64:67], v[72:75]
    ds_read_b64_tr_b16 a[62:63], v103 offset:25600
    v_mfma_f32_16x16x32_bf16 v[76:79], a[24:27], a[68:71], v[76:79]
    v_mfma_f32_16x16x32_bf16 v[80:83], a[24:27], a[72:75], v[80:83]
    v_mfma_f32_16x16x32_bf16 v[84:87], a[28:31], a[64:67], v[84:87]
    v_mfma_f32_16x16x32_bf16 v[88:91], a[28:31], a[68:71], v[88:91]
    v_mfma_f32_16x16x32_bf16 v[92:95], a[28:31], a[72:75], v[92:95]
    s_waitcnt lgkmcnt(0)
    s_barrier
    v_mfma_f32_16x16x32_bf16 v[0:3], a[32:35], a[76:79], v[0:3]
    ds_read_b128 a[64:67], v104 offset:49152
    v_mfma_f32_16x16x32_bf16 v[4:7], a[32:35], a[80:83], v[4:7]
    ds_read_b128 a[68:71], v104 offset:51200
    v_mfma_f32_16x16x32_bf16 v[8:11], a[32:35], a[84:87], v[8:11]
    ds_read_b128 a[72:75], v104 offset:53248
    v_mfma_f32_16x16x32_bf16 v[12:15], a[36:39], a[76:79], v[12:15]
    ds_read_b64_tr_b16 a[0:1], v96 offset:32768
    v_mfma_f32_16x16x32_bf16 v[16:19], a[36:39], a[80:83], v[16:19]
    ds_read_b64_tr_b16 a[2:3], v96 offset:33792
    v_mfma_f32_16x16x32_bf16 v[20:23], a[36:39], a[84:87], v[20:23]
    ds_read_b64_tr_b16 a[4:5], v97 offset:32768
    v_mfma_f32_16x16x32_bf16 v[24:27], a[40:43], a[76:79], v[24:27]
    ds_read_b64_tr_b16 a[6:7], v97 offset:33792
    v_mfma_f32_16x16x32_bf16 v[28:31], a[40:43], a[80:83], v[28:31]
    ds_read_b64_tr_b16 a[8:9], v98 offset:32768
    v_mfma_f32_16x16x32_bf16 v[32:35], a[40:43], a[84:87], v[32:35]
    ds_read_b64_tr_b16 a[10:11], v98 offset:33792
    v_mfma_f32_16x16x32_bf16 v[36:39], a[44:47], a[76:79], v[36:39]
    ds_read_b64_tr_b16 a[12:13], v99 offset:32768
    v_mfma_f32_16x16x32_bf16 v[40:43], a[44:47], a[80:83], v[40:43]
    ds_read_b64_tr_b16 a[14:15], v99 offset:33792
    v_mfma_f32_16x16x32_bf16 v[44:47], a[44:47], a[84:87], v[44:47]
    ds_read_b64_tr_b16 a[16:17], v100 offset:32768
    v_mfma_f32_16x16x32_bf16 v[48:51], a[48:51], a[76:79], v[48:51]
    ds_read_b64_tr_b16 a[18:19], v100 offset:33792
    v_mfma_f32_16x16x32_bf16 v[52:55], a[48:51], a[80:83], v[52:55]
    ds_read_b64_tr_b16 a[20:21], v101 offset:32768
    v_mfma_f32_16x16x32_bf16 v[56:59], a[48:51], a[84:87], v[56:59]
    ds_read_b64_tr_b16 a[22:23], v101 offset:33792
    v_mfma_f32_16x16x32_bf16 v[60:63], a[52:55], a[76:79], v[60:63]
    ds_read_b64_tr_b16 a[24:25], v102 offset:32768
    v_mfma_f32_16x16x32_bf16 v[64:67], a[52:55], a[80:83], v[64:67]
    ds_read_b64_tr_b16 a[26:27], v102 offset:33792
    v_mfma_f32_16x16x32_bf16 v[68:71], a[52:55], a[84:87], v[68:71]
    ds_read_b64_tr_b16 a[28:29], v103 offset:32768
    v_mfma_f32_16x16x32_bf16 v[72:75], a[56:59], a[76:79], v[72:75]
    ds_read_b64_tr_b16 a[30:31], v103 offset:33792
    v_mfma_f32_16x16x32_bf16 v[76:79], a[56:59], a[80:83], v[76:79]
    v_mfma_f32_16x16x32_bf16 v[80:83], a[56:59], a[84:87], v[80:83]
    v_mfma_f32_16x16x32_bf16 v[84:87], a[60:63], a[76:79], v[84:87]
    v_mfma_f32_16x16x32_bf16 v[88:91], a[60:63], a[80:83], v[88:91]
    v_mfma_f32_16x16x32_bf16 v[92:95], a[60:63], a[84:87], v[92:95]
    s_waitcnt lgkmcnt(0)
    s_barrier
    v_mfma_f32_16x16x32_bf16 v[0:3], a[0:3], a[64:67], v[0:3]
    ds_read_b128 a[76:79], v105 offset:49152
    v_mfma_f32_16x16x32_bf16 v[4:7], a[0:3], a[68:71], v[4:7]
    ds_read_b128 a[80:83], v105 offset:51200
    v_mfma_f32_16x16x32_bf16 v[8:11], a[0:3], a[72:75], v[8:11]
    ds_read_b128 a[84:87], v105 offset:53248
    v_mfma_f32_16x16x32_bf16 v[12:15], a[4:7], a[64:67], v[12:15]
    ds_read_b64_tr_b16 a[32:33], v96 offset:0
    v_mfma_f32_16x16x32_bf16 v[16:19], a[4:7], a[68:71], v[16:19]
    ds_read_b64_tr_b16 a[34:35], v96 offset:1024
    v_mfma_f32_16x16x32_bf16 v[20:23], a[4:7], a[72:75], v[20:23]
    ds_read_b64_tr_b16 a[36:37], v97 offset:0
    v_mfma_f32_16x16x32_bf16 v[24:27], a[8:11], a[64:67], v[24:27]
    ds_read_b64_tr_b16 a[38:39], v97 offset:1024
    v_mfma_f32_16x16x32_bf16 v[28:31], a[8:11], a[68:71], v[28:31]
    ds_read_b64_tr_b16 a[40:41], v98 offset:0
    v_mfma_f32_16x16x32_bf16 v[32:35], a[8:11], a[72:75], v[32:35]
    ds_read_b64_tr_b16 a[42:43], v98 offset:1024
    v_mfma_f32_16x16x32_bf16 v[36:39], a[12:15], a[64:67], v[36:39]
    ds_read_b64_tr_b16 a[44:45], v99 offset:0
    v_mfma_f32_16x16x32_bf16 v[40:43], a[12:15], a[68:71], v[40:43]
    ds_read_b64_tr_b16 a[46:47], v99 offset:1024
    v_mfma_f32_16x16x32_bf16 v[44:47], a[12:15], a[72:75], v[44:47]
    ds_read_b64_tr_b16 a[48:49], v100 offset:0
    v_mfma_f32_16x16x32_bf16 v[48:51], a[16:19], a[64:67], v[48:51]
    ds_read_b64_tr_b16 a[50:51], v100 offset:1024
    v_mfma_f32_16x16x32_bf16 v[52:55], a[16:19], a[68:71], v[52:55]
    ds_read_b64_tr_b16 a[52:53], v101 offset:0
    v_mfma_f32_16x16x32_bf16 v[56:59], a[16:19], a[72:75], v[56:59]
    ds_read_b64_tr_b16 a[54:55], v101 offset:1024
    v_mfma_f32_16x16x32_bf16 v[60:63], a[20:23], a[64:67], v[60:63]
    ds_read_b64_tr_b16 a[56:57], v102 offset:0
    v_mfma_f32_16x16x32_bf16 v[64:67], a[20:23], a[68:71], v[64:67]
    ds_read_b64_tr_b16 a[58:59], v102 offset:1024
    v_mfma_f32_16x16x32_bf16 v[68:71], a[20:23], a[72:75], v[68:71]
    ds_read_b64_tr_b16 a[60:61], v103 offset:0
    v_mfma_f32_16x16x32_bf16 v[72:75], a[24:27], a[64:67], v[72:75]
    ds_read_b64_tr_b16 a[62:63], v103 offset:1024
    v_mfma_f32_16x16x32_bf16 v[76:79], a[24:27], a[68:71], v[76:79]
    v_mfma_f32_16x16x32_bf16 v[80:83], a[24:27], a[72:75], v[80:83]
    v_mfma_f32_16x16x32_bf16 v[84:87], a[28:31], a[64:67], v[84:87]
    v_mfma_f32_16x16x32_bf16 v[88:91], a[28:31], a[68:71], v[88:91]
    v_mfma_f32_16x16x32_bf16 v[92:95], a[28:31], a[72:75], v[92:95]
    s_waitcnt lgkmcnt(0)
    s_barrier
    v_mfma_f32_16x16x32_bf16 v[0:3], a[32:35], a[76:79], v[0:3]
    ds_read_b128 a[64:67], v104 offset:0
    v_mfma_f32_16x16x32_bf16 v[4:7], a[32:35], a[80:83], v[4:7]
    ds_read_b128 a[68:71], v104 offset:2048
    v_mfma_f32_16x16x32_bf16 v[8:11], a[32:35], a[84:87], v[8:11]
    ds_read_b128 a[72:75], v104 offset:4096
    v_mfma_f32_16x16x32_bf16 v[12:15], a[36:39], a[76:79], v[12:15]
    ds_read_b64_tr_b16 a[0:1], v96 offset:8192
    v_mfma_f32_16x16x32_bf16 v[16:19], a[36:39], a[80:83], v[16:19]
    ds_read_b64_tr_b16 a[2:3], v96 offset:9216
    v_mfma_f32_16x16x32_bf16 v[20:23], a[36:39], a[84:87], v[20:23]
    ds_read_b64_tr_b16 a[4:5], v97 offset:8192
    v_mfma_f32_16x16x32_bf16 v[24:27], a[40:43], a[76:79], v[24:27]
    ds_read_b64_tr_b16 a[6:7], v97 offset:9216
    v_mfma_f32_16x16x32_bf16 v[28:31], a[40:43], a[80:83], v[28:31]
    ds_read_b64_tr_b16 a[8:9], v98 offset:8192
    v_mfma_f32_16x16x32_bf16 v[32:35], a[40:43], a[84:87], v[32:35]
    ds_read_b64_tr_b16 a[10:11], v98 offset:9216
    v_mfma_f32_16x16x32_bf16 v[36:39], a[44:47], a[76:79], v[36:39]
    ds_read_b64_tr_b16 a[12:13], v99 offset:8192
    v_mfma_f32_16x16x32_bf16 v[40:43], a[44:47], a[80:83], v[40:43]
    ds_read_b64_tr_b16 a[14:15], v99 offset:9216
    v_mfma_f32_16x16x32_bf16 v[44:47], a[44:47], a[84:87], v[44:47]
    ds_read_b64_tr_b16 a[16:17], v100 offset:8192
    v_mfma_f32_16x16x32_bf16 v[48:51], a[48:51], a[76:79], v[48:51]
    ds_read_b64_tr_b16 a[18:19], v100 offset:9216
    v_mfma_f32_16x16x32_bf16 v[52:55], a[48:51], a[80:83], v[52:55]
    ds_read_b64_tr_b16 a[20:21], v101 offset:8192
    v_mfma_f32_16x16x32_bf16 v[56:59], a[48:51], a[84:87], v[56:59]
    ds_read_b64_tr_b16 a[22:23], v101 offset:9216
    v_mfma_f32_16x16x32_bf16 v[60:63], a[52:55], a[76:79], v[60:63]
    ds_read_b64_tr_b16 a[24:25], v102 offset:8192
    v_mfma_f32_16x16x32_bf16 v[64:67], a[52:55], a[80:83], v[64:67]
    ds_read_b64_tr_b16 a[26:27], v102 offset:9216
    v_mfma_f32_16x16x32_bf16 v[68:71], a[52:55], a[84:87], v[68:71]
    ds_read_b64_tr_b16 a[28:29], v103 offset:8192
    v_mfma_f32_16x16x32_bf16 v[72:75], a[56:59], a[76:79], v[72:75]
    ds_read_b64_tr_b16 a[30:31], v103 offset:9216
    v_mfma_f32_16x16x32_bf16 v[76:79], a[56:59], a[80:83], v[76:79]
    v_mfma_f32_16x16x32_bf16 v[80:83], a[56:59], a[84:87], v[80:83]
    v_mfma_f32_16x16x32_bf16 v[84:87], a[60:63], a[76:79], v[84:87]
    v_mfma_f32_16x16x32_bf16 v[88:91], a[60:63], a[80:83], v[88:91]
    v_mfma_f32_16x16x32_bf16 v[92:95], a[60:63], a[84:87], v[92:95]
    s_waitcnt lgkmcnt(0)
    s_barrier
    v_mfma_f32_16x16x32_bf16 v[0:3], a[0:3], a[64:67], v[0:3]
    ds_read_b128 a[76:79], v105 offset:0
    v_mfma_f32_16x16x32_bf16 v[4:7], a[0:3], a[68:71], v[4:7]
    ds_read_b128 a[80:83], v105 offset:2048
    v_mfma_f32_16x16x32_bf16 v[8:11], a[0:3], a[72:75], v[8:11]
    ds_read_b128 a[84:87], v105 offset:4096
    v_mfma_f32_16x16x32_bf16 v[12:15], a[4:7], a[64:67], v[12:15]
    ds_read_b64_tr_b16 a[32:33], v96 offset:16384
    v_mfma_f32_16x16x32_bf16 v[16:19], a[4:7], a[68:71], v[16:19]
    ds_read_b64_tr_b16 a[34:35], v96 offset:17408
    v_mfma_f32_16x16x32_bf16 v[20:23], a[4:7], a[72:75], v[20:23]
    ds_read_b64_tr_b16 a[36:37], v97 offset:16384
    v_mfma_f32_16x16x32_bf16 v[24:27], a[8:11], a[64:67], v[24:27]
    ds_read_b64_tr_b16 a[38:39], v97 offset:17408
    v_mfma_f32_16x16x32_bf16 v[28:31], a[8:11], a[68:71], v[28:31]
    ds_read_b64_tr_b16 a[40:41], v98 offset:16384
    v_mfma_f32_16x16x32_bf16 v[32:35], a[8:11], a[72:75], v[32:35]
    ds_read_b64_tr_b16 a[42:43], v98 offset:17408
    v_mfma_f32_16x16x32_bf16 v[36:39], a[12:15], a[64:67], v[36:39]
    ds_read_b64_tr_b16 a[44:45], v99 offset:16384
    v_mfma_f32_16x16x32_bf16 v[40:43], a[12:15], a[68:71], v[40:43]
    ds_read_b64_tr_b16 a[46:47], v99 offset:17408
    v_mfma_f32_16x16x32_bf16 v[44:47], a[12:15], a[72:75], v[44:47]
    ds_read_b64_tr_b16 a[48:49], v100 offset:16384
    v_mfma_f32_16x16x32_bf16 v[48:51], a[16:19], a[64:67], v[48:51]
    ds_read_b64_tr_b16 a[50:51], v100 offset:17408
    v_mfma_f32_16x16x32_bf16 v[52:55], a[16:19], a[68:71], v[52:55]
    ds_read_b64_tr_b16 a[52:53], v101 offset:16384
    v_mfma_f32_16x16x32_bf16 v[56:59], a[16:19], a[72:75], v[56:59]
    ds_read_b64_tr_b16 a[54:55], v101 offset:17408
    v_mfma_f32_16x16x32_bf16 v[60:63], a[20:23], a[64:67], v[60:63]
    ds_read_b64_tr_b16 a[56:57], v102 offset:16384
    v_mfma_f32_16x16x32_bf16 v[64:67], a[20:23], a[68:71], v[64:67]
    ds_read_b64_tr_b16 a[58:59], v102 offset:17408
    v_mfma_f32_16x16x32_bf16 v[68:71], a[20:23], a[72:75], v[68:71]
    ds_read_b64_tr_b16 a[60:61], v103 offset:16384
    v_mfma_f32_16x16x32_bf16 v[72:75], a[24:27], a[64:67], v[72:75]
    ds_read_b64_tr_b16 a[62:63], v103 offset:17408
    v_mfma_f32_16x16x32_bf16 v[76:79], a[24:27], a[68:71], v[76:79]
    v_mfma_f32_16x16x32_bf16 v[80:83], a[24:27], a[72:75], v[80:83]
    v_mfma_f32_16x16x32_bf16 v[84:87], a[28:31], a[64:67], v[84:87]
    v_mfma_f32_16x16x32_bf16 v[88:91], a[28:31], a[68:71], v[88:91]
    v_mfma_f32_16x16x32_bf16 v[92:95], a[28:31], a[72:75], v[92:95]
    s_waitcnt lgkmcnt(0)
    s_barrier
    v_mfma_f32_16x16x32_bf16 v[0:3], a[32:35], a[76:79], v[0:3]
    ds_read_b128 a[64:67], v104 offset:24576
    v_mfma_f32_16x16x32_bf16 v[4:7], a[32:35], a[80:83], v[4:7]
    ds_read_b128 a[68:71], v104 offset:26624
    v_mfma_f32_16x16x32_bf16 v[8:11], a[32:35], a[84:87], v[8:11]
    ds_read_b128 a[72:75], v104 offset:28672
    v_mfma_f32_16x16x32_bf16 v[12:15], a[36:39], a[76:79], v[12:15]
    ds_read_b64_tr_b16 a[0:1], v96 offset:24576
    v_mfma_f32_16x16x32_bf16 v[16:19], a[36:39], a[80:83], v[16:19]
    ds_read_b64_tr_b16 a[2:3], v96 offset:25600
    v_mfma_f32_16x16x32_bf16 v[20:23], a[36:39], a[84:87], v[20:23]
    ds_read_b64_tr_b16 a[4:5], v97 offset:24576
    v_mfma_f32_16x16x32_bf16 v[24:27], a[40:43], a[76:79], v[24:27]
    ds_read_b64_tr_b16 a[6:7], v97 offset:25600
    v_mfma_f32_16x16x32_bf16 v[28:31], a[40:43], a[80:83], v[28:31]
    ds_read_b64_tr_b16 a[8:9], v98 offset:24576
    v_mfma_f32_16x16x32_bf16 v[32:35], a[40:43], a[84:87], v[32:35]
    ds_read_b64_tr_b16 a[10:11], v98 offset:25600
    v_mfma_f32_16x16x32_bf16 v[36:39], a[44:47], a[76:79], v[36:39]
    ds_read_b64_tr_b16 a[12:13], v99 offset:24576
    v_mfma_f32_16x16x32_bf16 v[40:43], a[44:47], a[80:83], v[40:43]
    ds_read_b64_tr_b16 a[14:15], v99 offset:25600
    v_mfma_f32_16x16x32_bf16 v[44:47], a[44:47], a[84:87], v[44:47]
    ds_read_b64_tr_b16 a[16:17], v100 offset:24576
    v_mfma_f32_16x16x32_bf16 v[48:51], a[48:51], a[76:79], v[48:51]
    ds_read_b64_tr_b16 a[18:19], v100 offset:25600
    v_mfma_f32_16x16x32_bf16 v[52:55], a[48:51], a[80:83], v[52:55]
    ds_read_b64_tr_b16 a[20:21], v101 offset:24576
    v_mfma_f32_16x16x32_bf16 v[56:59], a[48:51], a[84:87], v[56:59]
    ds_read_b64_tr_b16 a[22:23], v101 offset:25600
    v_mfma_f32_16x16x32_bf16 v[60:63], a[52:55], a[76:79], v[60:63]
    ds_read_b64_tr_b16 a[24:25], v102 offset:24576
    v_mfma_f32_16x16x32_bf16 v[64:67], a[52:55], a[80:83], v[64:67]
    ds_read_b64_tr_b16 a[26:27], v102 offset:25600
    v_mfma_f32_16x16x32_bf16 v[68:71], a[52:55], a[84:87], v[68:71]
    ds_read_b64_tr_b16 a[28:29], v103 offset:24576
    v_mfma_f32_16x16x32_bf16 v[72:75], a[56:59], a[76:79], v[72:75]
    ds_read_b64_tr_b16 a[30:31], v103 offset:25600
    v_mfma_f32_16x16x32_bf16 v[76:79], a[56:59], a[80:83], v[76:79]
    v_mfma_f32_16x16x32_bf16 v[80:83], a[56:59], a[84:87], v[80:83]
    v_mfma_f32_16x16x32_bf16 v[84:87], a[60:63], a[76:79], v[84:87]
    v_mfma_f32_16x16x32_bf16 v[88:91], a[60:63], a[80:83], v[88:91]
    v_mfma_f32_16x16x32_bf16 v[92:95], a[60:63], a[84:87], v[92:95]
    s_waitcnt lgkmcnt(0)
    s_barrier
    v_mfma_f32_16x16x32_bf16 v[0:3], a[0:3], a[64:67], v[0:3]
    ds_read_b128 a[76:79], v105 offset:24576
    v_mfma_f32_16x16x32_bf16 v[4:7], a[0:3], a[68:71], v[4:7]
    ds_read_b128 a[80:83], v105 offset:26624
    v_mfma_f32_16x16x32_bf16 v[8:11], a[0:3], a[72:75], v[8:11]
    ds_read_b128 a[84:87], v105 offset:28672
    v_mfma_f32_16x16x32_bf16 v[12:15], a[4:7], a[64:67], v[12:15]
    ds_read_b64_tr_b16 a[32:33], v96 offset:32768
    v_mfma_f32_16x16x32_bf16 v[16:19], a[4:7], a[68:71], v[16:19]
    ds_read_b64_tr_b16 a[34:35], v96 offset:33792
    v_mfma_f32_16x16x32_bf16 v[20:23], a[4:7], a[72:75], v[20:23]
    ds_read_b64_tr_b16 a[36:37], v97 offset:32768
    v_mfma_f32_16x16x32_bf16 v[24:27], a[8:11], a[64:67], v[24:27]
    ds_read_b64_tr_b16 a[38:39], v97 offset:33792
    v_mfma_f32_16x16x32_bf16 v[28:31], a[8:11], a[68:71], v[28:31]
    ds_read_b64_tr_b16 a[40:41], v98 offset:32768
    v_mfma_f32_16x16x32_bf16 v[32:35], a[8:11], a[72:75], v[32:35]
    ds_read_b64_tr_b16 a[42:43], v98 offset:33792
    v_mfma_f32_16x16x32_bf16 v[36:39], a[12:15], a[64:67], v[36:39]
    ds_read_b64_tr_b16 a[44:45], v99 offset:32768
    v_mfma_f32_16x16x32_bf16 v[40:43], a[12:15], a[68:71], v[40:43]
    ds_read_b64_tr_b16 a[46:47], v99 offset:33792
    v_mfma_f32_16x16x32_bf16 v[44:47], a[12:15], a[72:75], v[44:47]
    ds_read_b64_tr_b16 a[48:49], v100 offset:32768
    v_mfma_f32_16x16x32_bf16 v[48:51], a[16:19], a[64:67], v[48:51]
    ds_read_b64_tr_b16 a[50:51], v100 offset:33792
    v_mfma_f32_16x16x32_bf16 v[52:55], a[16:19], a[68:71], v[52:55]
    ds_read_b64_tr_b16 a[52:53], v101 offset:32768
    v_mfma_f32_16x16x32_bf16 v[56:59], a[16:19], a[72:75], v[56:59]
    ds_read_b64_tr_b16 a[54:55], v101 offset:33792
    v_mfma_f32_16x16x32_bf16 v[60:63], a[20:23], a[64:67], v[60:63]
    ds_read_b64_tr_b16 a[56:57], v102 offset:32768
    v_mfma_f32_16x16x32_bf16 v[64:67], a[20:23], a[68:71], v[64:67]
    ds_read_b64_tr_b16 a[58:59], v102 offset:33792
    v_mfma_f32_16x16x32_bf16 v[68:71], a[20:23], a[72:75], v[68:71]
    ds_read_b64_tr_b16 a[60:61], v103 offset:32768
    v_mfma_f32_16x16x32_bf16 v[72:75], a[24:27], a[64:67], v[72:75]
    ds_read_b64_tr_b16 a[62:63], v103 offset:33792
    v_mfma_f32_16x16x32_bf16 v[76:79], a[24:27], a[68:71], v[76:79]
    v_mfma_f32_16x16x32_bf16 v[80:83], a[24:27], a[72:75], v[80:83]
    v_mfma_f32_16x16x32_bf16 v[84:87], a[28:31], a[64:67], v[84:87]
    v_mfma_f32_16x16x32_bf16 v[88:91], a[28:31], a[68:71], v[88:91]
    v_mfma_f32_16x16x32_bf16 v[92:95], a[28:31], a[72:75], v[92:95]
    s_waitcnt lgkmcnt(0)
    s_barrier
    v_mfma_f32_16x16x32_bf16 v[0:3], a[32:35], a[76:79], v[0:3]
    ds_read_b128 a[64:67], v104 offset:49152
    v_mfma_f32_16x16x32_bf16 v[4:7], a[32:35], a[80:83], v[4:7]
    ds_read_b128 a[68:71], v104 offset:51200
    v_mfma_f32_16x16x32_bf16 v[8:11], a[32:35], a[84:87], v[8:11]
    ds_read_b128 a[72:75], v104 offset:53248
    v_mfma_f32_16x16x32_bf16 v[12:15], a[36:39], a[76:79], v[12:15]
    ds_read_b64_tr_b16 a[0:1], v96 offset:0
    v_mfma_f32_16x16x32_bf16 v[16:19], a[36:39], a[80:83], v[16:19]
    ds_read_b64_tr_b16 a[2:3], v96 offset:1024
    v_mfma_f32_16x16x32_bf16 v[20:23], a[36:39], a[84:87], v[20:23]
    ds_read_b64_tr_b16 a[4:5], v97 offset:0
    v_mfma_f32_16x16x32_bf16 v[24:27], a[40:43], a[76:79], v[24:27]
    ds_read_b64_tr_b16 a[6:7], v97 offset:1024
    v_mfma_f32_16x16x32_bf16 v[28:31], a[40:43], a[80:83], v[28:31]
    ds_read_b64_tr_b16 a[8:9], v98 offset:0
    v_mfma_f32_16x16x32_bf16 v[32:35], a[40:43], a[84:87], v[32:35]
    ds_read_b64_tr_b16 a[10:11], v98 offset:1024
    v_mfma_f32_16x16x32_bf16 v[36:39], a[44:47], a[76:79], v[36:39]
    ds_read_b64_tr_b16 a[12:13], v99 offset:0
    v_mfma_f32_16x16x32_bf16 v[40:43], a[44:47], a[80:83], v[40:43]
    ds_read_b64_tr_b16 a[14:15], v99 offset:1024
    v_mfma_f32_16x16x32_bf16 v[44:47], a[44:47], a[84:87], v[44:47]
    ds_read_b64_tr_b16 a[16:17], v100 offset:0
    v_mfma_f32_16x16x32_bf16 v[48:51], a[48:51], a[76:79], v[48:51]
    ds_read_b64_tr_b16 a[18:19], v100 offset:1024
    v_mfma_f32_16x16x32_bf16 v[52:55], a[48:51], a[80:83], v[52:55]
    ds_read_b64_tr_b16 a[20:21], v101 offset:0
    v_mfma_f32_16x16x32_bf16 v[56:59], a[48:51], a[84:87], v[56:59]
    ds_read_b64_tr_b16 a[22:23], v101 offset:1024
    v_mfma_f32_16x16x32_bf16 v[60:63], a[52:55], a[76:79], v[60:63]
    ds_read_b64_tr_b16 a[24:25], v102 offset:0
    v_mfma_f32_16x16x32_bf16 v[64:67], a[52:55], a[80:83], v[64:67]
    ds_read_b64_tr_b16 a[26:27], v102 offset:1024
    v_mfma_f32_16x16x32_bf16 v[68:71], a[52:55], a[84:87], v[68:71]
    ds_read_b64_tr_b16 a[28:29], v103 offset:0
    v_mfma_f32_16x16x32_bf16 v[72:75], a[56:59], a[76:79], v[72:75]
    ds_read_b64_tr_b16 a[30:31], v103 offset:1024
    v_mfma_f32_16x16x32_bf16 v[76:79], a[56:59], a[80:83], v[76:79]
    v_mfma_f32_16x16x32_bf16 v[80:83], a[56:59], a[84:87], v[80:83]
    v_mfma_f32_16x16x32_bf16 v[84:87], a[60:63], a[76:79], v[84:87]
    v_mfma_f32_16x16x32_bf16 v[88:91], a[60:63], a[80:83], v[88:91]
    v_mfma_f32_16x16x32_bf16 v[92:95], a[60:63], a[84:87], v[92:95]
    s_waitcnt lgkmcnt(0)
    s_barrier
    v_mfma_f32_16x16x32_bf16 v[0:3], a[0:3], a[64:67], v[0:3]
    ds_read_b128 a[76:79], v105 offset:49152
    v_mfma_f32_16x16x32_bf16 v[4:7], a[0:3], a[68:71], v[4:7]
    ds_read_b128 a[80:83], v105 offset:51200
    v_mfma_f32_16x16x32_bf16 v[8:11], a[0:3], a[72:75], v[8:11]
    ds_read_b128 a[84:87], v105 offset:53248
    v_mfma_f32_16x16x32_bf16 v[12:15], a[4:7], a[64:67], v[12:15]
    ds_read_b64_tr_b16 a[32:33], v96 offset:8192
    v_mfma_f32_16x16x32_bf16 v[16:19], a[4:7], a[68:71], v[16:19]
    ds_read_b64_tr_b16 a[34:35], v96 offset:9216
    v_mfma_f32_16x16x32_bf16 v[20:23], a[4:7], a[72:75], v[20:23]
    ds_read_b64_tr_b16 a[36:37], v97 offset:8192
    v_mfma_f32_16x16x32_bf16 v[24:27], a[8:11], a[64:67], v[24:27]
    ds_read_b64_tr_b16 a[38:39], v97 offset:9216
    v_mfma_f32_16x16x32_bf16 v[28:31], a[8:11], a[68:71], v[28:31]
    ds_read_b64_tr_b16 a[40:41], v98 offset:8192
    v_mfma_f32_16x16x32_bf16 v[32:35], a[8:11], a[72:75], v[32:35]
    ds_read_b64_tr_b16 a[42:43], v98 offset:9216
    v_mfma_f32_16x16x32_bf16 v[36:39], a[12:15], a[64:67], v[36:39]
    ds_read_b64_tr_b16 a[44:45], v99 offset:8192
    v_mfma_f32_16x16x32_bf16 v[40:43], a[12:15], a[68:71], v[40:43]
    ds_read_b64_tr_b16 a[46:47], v99 offset:9216
    v_mfma_f32_16x16x32_bf16 v[44:47], a[12:15], a[72:75], v[44:47]
    ds_read_b64_tr_b16 a[48:49], v100 offset:8192
    v_mfma_f32_16x16x32_bf16 v[48:51], a[16:19], a[64:67], v[48:51]
    ds_read_b64_tr_b16 a[50:51], v100 offset:9216
    v_mfma_f32_16x16x32_bf16 v[52:55], a[16:19], a[68:71], v[52:55]
    ds_read_b64_tr_b16 a[52:53], v101 offset:8192
    v_mfma_f32_16x16x32_bf16 v[56:59], a[16:19], a[72:75], v[56:59]
    ds_read_b64_tr_b16 a[54:55], v101 offset:9216
    v_mfma_f32_16x16x32_bf16 v[60:63], a[20:23], a[64:67], v[60:63]
    ds_read_b64_tr_b16 a[56:57], v102 offset:8192
    v_mfma_f32_16x16x32_bf16 v[64:67], a[20:23], a[68:71], v[64:67]
    ds_read_b64_tr_b16 a[58:59], v102 offset:9216
    v_mfma_f32_16x16x32_bf16 v[68:71], a[20:23], a[72:75], v[68:71]
    ds_read_b64_tr_b16 a[60:61], v103 offset:8192
    v_mfma_f32_16x16x32_bf16 v[72:75], a[24:27], a[64:67], v[72:75]
    ds_read_b64_tr_b16 a[62:63], v103 offset:9216
    v_mfma_f32_16x16x32_bf16 v[76:79], a[24:27], a[68:71], v[76:79]
    v_mfma_f32_16x16x32_bf16 v[80:83], a[24:27], a[72:75], v[80:83]
    v_mfma_f32_16x16x32_bf16 v[84:87], a[28:31], a[64:67], v[84:87]
    v_mfma_f32_16x16x32_bf16 v[88:91], a[28:31], a[68:71], v[88:91]
    v_mfma_f32_16x16x32_bf16 v[92:95], a[28:31], a[72:75], v[92:95]
    s_waitcnt lgkmcnt(0)
    s_barrier
    v_mfma_f32_16x16x32_bf16 v[0:3], a[32:35], a[76:79], v[0:3]
    ds_read_b128 a[64:67], v104 offset:0
    v_mfma_f32_16x16x32_bf16 v[4:7], a[32:35], a[80:83], v[4:7]
    ds_read_b128 a[68:71], v104 offset:2048
    v_mfma_f32_16x16x32_bf16 v[8:11], a[32:35], a[84:87], v[8:11]
    ds_read_b128 a[72:75], v104 offset:4096
    v_mfma_f32_16x16x32_bf16 v[12:15], a[36:39], a[76:79], v[12:15]
    ds_read_b64_tr_b16 a[0:1], v96 offset:16384
    v_mfma_f32_16x16x32_bf16 v[16:19], a[36:39], a[80:83], v[16:19]
    ds_read_b64_tr_b16 a[2:3], v96 offset:17408
    v_mfma_f32_16x16x32_bf16 v[20:23], a[36:39], a[84:87], v[20:23]
    ds_read_b64_tr_b16 a[4:5], v97 offset:16384
    v_mfma_f32_16x16x32_bf16 v[24:27], a[40:43], a[76:79], v[24:27]
    ds_read_b64_tr_b16 a[6:7], v97 offset:17408
    v_mfma_f32_16x16x32_bf16 v[28:31], a[40:43], a[80:83], v[28:31]
    ds_read_b64_tr_b16 a[8:9], v98 offset:16384
    v_mfma_f32_16x16x32_bf16 v[32:35], a[40:43], a[84:87], v[32:35]
    ds_read_b64_tr_b16 a[10:11], v98 offset:17408
    v_mfma_f32_16x16x32_bf16 v[36:39], a[44:47], a[76:79], v[36:39]
    ds_read_b64_tr_b16 a[12:13], v99 offset:16384
    v_mfma_f32_16x16x32_bf16 v[40:43], a[44:47], a[80:83], v[40:43]
    ds_read_b64_tr_b16 a[14:15], v99 offset:17408
    v_mfma_f32_16x16x32_bf16 v[44:47], a[44:47], a[84:87], v[44:47]
    ds_read_b64_tr_b16 a[16:17], v100 offset:16384
    v_mfma_f32_16x16x32_bf16 v[48:51], a[48:51], a[76:79], v[48:51]
    ds_read_b64_tr_b16 a[18:19], v100 offset:17408
    v_mfma_f32_16x16x32_bf16 v[52:55], a[48:51], a[80:83], v[52:55]
    ds_read_b64_tr_b16 a[20:21], v101 offset:16384
    v_mfma_f32_16x16x32_bf16 v[56:59], a[48:51], a[84:87], v[56:59]
    ds_read_b64_tr_b16 a[22:23], v101 offset:17408
    v_mfma_f32_16x16x32_bf16 v[60:63], a[52:55], a[76:79], v[60:63]
    ds_read_b64_tr_b16 a[24:25], v102 offset:16384
    v_mfma_f32_16x16x32_bf16 v[64:67], a[52:55], a[80:83], v[64:67]
    ds_read_b64_tr_b16 a[26:27], v102 offset:17408
    v_mfma_f32_16x16x32_bf16 v[68:71], a[52:55], a[84:87], v[68:71]
    ds_read_b64_tr_b16 a[28:29], v103 offset:16384
    v_mfma_f32_16x16x32_bf16 v[72:75], a[56:59], a[76:79], v[72:75]
    ds_read_b64_tr_b16 a[30:31], v103 offset:17408
    v_mfma_f32_16x16x32_bf16 v[76:79], a[56:59], a[80:83], v[76:79]
    v_mfma_f32_16x16x32_bf16 v[80:83], a[56:59], a[84:87], v[80:83]
    v_mfma_f32_16x16x32_bf16 v[84:87], a[60:63], a[76:79], v[84:87]
    v_mfma_f32_16x16x32_bf16 v[88:91], a[60:63], a[80:83], v[88:91]
    v_mfma_f32_16x16x32_bf16 v[92:95], a[60:63], a[84:87], v[92:95]
    s_waitcnt lgkmcnt(0)
    s_barrier
    v_mfma_f32_16x16x32_bf16 v[0:3], a[0:3], a[64:67], v[0:3]
    ds_read_b128 a[76:79], v105 offset:0
    v_mfma_f32_16x16x32_bf16 v[4:7], a[0:3], a[68:71], v[4:7]
    ds_read_b128 a[80:83], v105 offset:2048
    v_mfma_f32_16x16x32_bf16 v[8:11], a[0:3], a[72:75], v[8:11]
    ds_read_b128 a[84:87], v105 offset:4096
    v_mfma_f32_16x16x32_bf16 v[12:15], a[4:7], a[64:67], v[12:15]
    ds_read_b64_tr_b16 a[32:33], v96 offset:24576
    v_mfma_f32_16x16x32_bf16 v[16:19], a[4:7], a[68:71], v[16:19]
    ds_read_b64_tr_b16 a[34:35], v96 offset:25600
    v_mfma_f32_16x16x32_bf16 v[20:23], a[4:7], a[72:75], v[20:23]
    ds_read_b64_tr_b16 a[36:37], v97 offset:24576
    v_mfma_f32_16x16x32_bf16 v[24:27], a[8:11], a[64:67], v[24:27]
    ds_read_b64_tr_b16 a[38:39], v97 offset:25600
    v_mfma_f32_16x16x32_bf16 v[28:31], a[8:11], a[68:71], v[28:31]
    ds_read_b64_tr_b16 a[40:41], v98 offset:24576
    v_mfma_f32_16x16x32_bf16 v[32:35], a[8:11], a[72:75], v[32:35]
    ds_read_b64_tr_b16 a[42:43], v98 offset:25600
    v_mfma_f32_16x16x32_bf16 v[36:39], a[12:15], a[64:67], v[36:39]
    ds_read_b64_tr_b16 a[44:45], v99 offset:24576
    v_mfma_f32_16x16x32_bf16 v[40:43], a[12:15], a[68:71], v[40:43]
    ds_read_b64_tr_b16 a[46:47], v99 offset:25600
    v_mfma_f32_16x16x32_bf16 v[44:47], a[12:15], a[72:75], v[44:47]
    ds_read_b64_tr_b16 a[48:49], v100 offset:24576
    v_mfma_f32_16x16x32_bf16 v[48:51], a[16:19], a[64:67], v[48:51]
    ds_read_b64_tr_b16 a[50:51], v100 offset:25600
    v_mfma_f32_16x16x32_bf16 v[52:55], a[16:19], a[68:71], v[52:55]
    ds_read_b64_tr_b16 a[52:53], v101 offset:24576
    v_mfma_f32_16x16x32_bf16 v[56:59], a[16:19], a[72:75], v[56:59]
    ds_read_b64_tr_b16 a[54:55], v101 offset:25600
    v_mfma_f32_16x16x32_bf16 v[60:63], a[20:23], a[64:67], v[60:63]
    ds_read_b64_tr_b16 a[56:57], v102 offset:24576
    v_mfma_f32_16x16x32_bf16 v[64:67], a[20:23], a[68:71], v[64:67]
    ds_read_b64_tr_b16 a[58:59], v102 offset:25600
    v_mfma_f32_16x16x32_bf16 v[68:71], a[20:23], a[72:75], v[68:71]
    ds_read_b64_tr_b16 a[60:61], v103 offset:24576
    v_mfma_f32_16x16x32_bf16 v[72:75], a[24:27], a[64:67], v[72:75]
    ds_read_b64_tr_b16 a[62:63], v103 offset:25600
    v_mfma_f32_16x16x32_bf16 v[76:79], a[24:27], a[68:71], v[76:79]
    v_mfma_f32_16x16x32_bf16 v[80:83], a[24:27], a[72:75], v[80:83]
    v_mfma_f32_16x16x32_bf16 v[84:87], a[28:31], a[64:67], v[84:87]
    v_mfma_f32_16x16x32_bf16 v[88:91], a[28:31], a[68:71], v[88:91]
    v_mfma_f32_16x16x32_bf16 v[92:95], a[28:31], a[72:75], v[92:95]
    s_waitcnt lgkmcnt(0)
    s_barrier
    v_mfma_f32_16x16x32_bf16 v[0:3], a[32:35], a[76:79], v[0:3]
    ds_read_b128 a[64:67], v104 offset:24576
    v_mfma_f32_16x16x32_bf16 v[4:7], a[32:35], a[80:83], v[4:7]
    ds_read_b128 a[68:71], v104 offset:26624
    v_mfma_f32_16x16x32_bf16 v[8:11], a[32:35], a[84:87], v[8:11]
    ds_read_b128 a[72:75], v104 offset:28672
    v_mfma_f32_16x16x32_bf16 v[12:15], a[36:39], a[76:79], v[12:15]
    ds_read_b64_tr_b16 a[0:1], v96 offset:32768
    v_mfma_f32_16x16x32_bf16 v[16:19], a[36:39], a[80:83], v[16:19]
    ds_read_b64_tr_b16 a[2:3], v96 offset:33792
    v_mfma_f32_16x16x32_bf16 v[20:23], a[36:39], a[84:87], v[20:23]
    ds_read_b64_tr_b16 a[4:5], v97 offset:32768
    v_mfma_f32_16x16x32_bf16 v[24:27], a[40:43], a[76:79], v[24:27]
    ds_read_b64_tr_b16 a[6:7], v97 offset:33792
    v_mfma_f32_16x16x32_bf16 v[28:31], a[40:43], a[80:83], v[28:31]
    ds_read_b64_tr_b16 a[8:9], v98 offset:32768
    v_mfma_f32_16x16x32_bf16 v[32:35], a[40:43], a[84:87], v[32:35]
    ds_read_b64_tr_b16 a[10:11], v98 offset:33792
    v_mfma_f32_16x16x32_bf16 v[36:39], a[44:47], a[76:79], v[36:39]
    ds_read_b64_tr_b16 a[12:13], v99 offset:32768
    v_mfma_f32_16x16x32_bf16 v[40:43], a[44:47], a[80:83], v[40:43]
    ds_read_b64_tr_b16 a[14:15], v99 offset:33792
    v_mfma_f32_16x16x32_bf16 v[44:47], a[44:47], a[84:87], v[44:47]
    ds_read_b64_tr_b16 a[16:17], v100 offset:32768
    v_mfma_f32_16x16x32_bf16 v[48:51], a[48:51], a[76:79], v[48:51]
    ds_read_b64_tr_b16 a[18:19], v100 offset:33792
    v_mfma_f32_16x16x32_bf16 v[52:55], a[48:51], a[80:83], v[52:55]
    ds_read_b64_tr_b16 a[20:21], v101 offset:32768
    v_mfma_f32_16x16x32_bf16 v[56:59], a[48:51], a[84:87], v[56:59]
    ds_read_b64_tr_b16 a[22:23], v101 offset:33792
    v_mfma_f32_16x16x32_bf16 v[60:63], a[52:55], a[76:79], v[60:63]
    ds_read_b64_tr_b16 a[24:25], v102 offset:32768
    v_mfma_f32_16x16x32_bf16 v[64:67], a[52:55], a[80:83], v[64:67]
    ds_read_b64_tr_b16 a[26:27], v102 offset:33792
    v_mfma_f32_16x16x32_bf16 v[68:71], a[52:55], a[84:87], v[68:71]
    ds_read_b64_tr_b16 a[28:29], v103 offset:32768
    v_mfma_f32_16x16x32_bf16 v[72:75], a[56:59], a[76:79], v[72:75]
    ds_read_b64_tr_b16 a[30:31], v103 offset:33792
    v_mfma_f32_16x16x32_bf16 v[76:79], a[56:59], a[80:83], v[76:79]
    v_mfma_f32_16x16x32_bf16 v[80:83], a[56:59], a[84:87], v[80:83]
    v_mfma_f32_16x16x32_bf16 v[84:87], a[60:63], a[76:79], v[84:87]
    v_mfma_f32_16x16x32_bf16 v[88:91], a[60:63], a[80:83], v[88:91]
    v_mfma_f32_16x16x32_bf16 v[92:95], a[60:63], a[84:87], v[92:95]
    s_waitcnt lgkmcnt(0)
    s_barrier
    v_mfma_f32_16x16x32_bf16 v[0:3], a[0:3], a[64:67], v[0:3]
    ds_read_b128 a[76:79], v105 offset:24576
    v_mfma_f32_16x16x32_bf16 v[4:7], a[0:3], a[68:71], v[4:7]
    ds_read_b128 a[80:83], v105 offset:26624
    v_mfma_f32_16x16x32_bf16 v[8:11], a[0:3], a[72:75], v[8:11]
    ds_read_b128 a[84:87], v105 offset:28672
    v_mfma_f32_16x16x32_bf16 v[12:15], a[4:7], a[64:67], v[12:15]
    ds_read_b64_tr_b16 a[32:33], v96 offset:0
    v_mfma_f32_16x16x32_bf16 v[16:19], a[4:7], a[68:71], v[16:19]
    ds_read_b64_tr_b16 a[34:35], v96 offset:1024
    v_mfma_f32_16x16x32_bf16 v[20:23], a[4:7], a[72:75], v[20:23]
    ds_read_b64_tr_b16 a[36:37], v97 offset:0
    v_mfma_f32_16x16x32_bf16 v[24:27], a[8:11], a[64:67], v[24:27]
    ds_read_b64_tr_b16 a[38:39], v97 offset:1024
    v_mfma_f32_16x16x32_bf16 v[28:31], a[8:11], a[68:71], v[28:31]
    ds_read_b64_tr_b16 a[40:41], v98 offset:0
    v_mfma_f32_16x16x32_bf16 v[32:35], a[8:11], a[72:75], v[32:35]
    ds_read_b64_tr_b16 a[42:43], v98 offset:1024
    v_mfma_f32_16x16x32_bf16 v[36:39], a[12:15], a[64:67], v[36:39]
    ds_read_b64_tr_b16 a[44:45], v99 offset:0
    v_mfma_f32_16x16x32_bf16 v[40:43], a[12:15], a[68:71], v[40:43]
    ds_read_b64_tr_b16 a[46:47], v99 offset:1024
    v_mfma_f32_16x16x32_bf16 v[44:47], a[12:15], a[72:75], v[44:47]
    ds_read_b64_tr_b16 a[48:49], v100 offset:0
    v_mfma_f32_16x16x32_bf16 v[48:51], a[16:19], a[64:67], v[48:51]
    ds_read_b64_tr_b16 a[50:51], v100 offset:1024
    v_mfma_f32_16x16x32_bf16 v[52:55], a[16:19], a[68:71], v[52:55]
    ds_read_b64_tr_b16 a[52:53], v101 offset:0
    v_mfma_f32_16x16x32_bf16 v[56:59], a[16:19], a[72:75], v[56:59]
    ds_read_b64_tr_b16 a[54:55], v101 offset:1024
    v_mfma_f32_16x16x32_bf16 v[60:63], a[20:23], a[64:67], v[60:63]
    ds_read_b64_tr_b16 a[56:57], v102 offset:0
    v_mfma_f32_16x16x32_bf16 v[64:67], a[20:23], a[68:71], v[64:67]
    ds_read_b64_tr_b16 a[58:59], v102 offset:1024
    v_mfma_f32_16x16x32_bf16 v[68:71], a[20:23], a[72:75], v[68:71]
    ds_read_b64_tr_b16 a[60:61], v103 offset:0
    v_mfma_f32_16x16x32_bf16 v[72:75], a[24:27], a[64:67], v[72:75]
    ds_read_b64_tr_b16 a[62:63], v103 offset:1024
    v_mfma_f32_16x16x32_bf16 v[76:79], a[24:27], a[68:71], v[76:79]
    v_mfma_f32_16x16x32_bf16 v[80:83], a[24:27], a[72:75], v[80:83]
    v_mfma_f32_16x16x32_bf16 v[84:87], a[28:31], a[64:67], v[84:87]
    v_mfma_f32_16x16x32_bf16 v[88:91], a[28:31], a[68:71], v[88:91]
    v_mfma_f32_16x16x32_bf16 v[92:95], a[28:31], a[72:75], v[92:95]
    s_waitcnt lgkmcnt(0)
    s_barrier
    v_mfma_f32_16x16x32_bf16 v[0:3], a[32:35], a[76:79], v[0:3]
    ds_read_b128 a[64:67], v104 offset:49152
    v_mfma_f32_16x16x32_bf16 v[4:7], a[32:35], a[80:83], v[4:7]
    ds_read_b128 a[68:71], v104 offset:51200
    v_mfma_f32_16x16x32_bf16 v[8:11], a[32:35], a[84:87], v[8:11]
    ds_read_b128 a[72:75], v104 offset:53248
    v_mfma_f32_16x16x32_bf16 v[12:15], a[36:39], a[76:79], v[12:15]
    ds_read_b64_tr_b16 a[0:1], v96 offset:8192
    v_mfma_f32_16x16x32_bf16 v[16:19], a[36:39], a[80:83], v[16:19]
    ds_read_b64_tr_b16 a[2:3], v96 offset:9216
    v_mfma_f32_16x16x32_bf16 v[20:23], a[36:39], a[84:87], v[20:23]
    ds_read_b64_tr_b16 a[4:5], v97 offset:8192
    v_mfma_f32_16x16x32_bf16 v[24:27], a[40:43], a[76:79], v[24:27]
    ds_read_b64_tr_b16 a[6:7], v97 offset:9216
    v_mfma_f32_16x16x32_bf16 v[28:31], a[40:43], a[80:83], v[28:31]
    ds_read_b64_tr_b16 a[8:9], v98 offset:8192
    v_mfma_f32_16x16x32_bf16 v[32:35], a[40:43], a[84:87], v[32:35]
    ds_read_b64_tr_b16 a[10:11], v98 offset:9216
    v_mfma_f32_16x16x32_bf16 v[36:39], a[44:47], a[76:79], v[36:39]
    ds_read_b64_tr_b16 a[12:13], v99 offset:8192
    v_mfma_f32_16x16x32_bf16 v[40:43], a[44:47], a[80:83], v[40:43]
    ds_read_b64_tr_b16 a[14:15], v99 offset:9216
    v_mfma_f32_16x16x32_bf16 v[44:47], a[44:47], a[84:87], v[44:47]
    ds_read_b64_tr_b16 a[16:17], v100 offset:8192
    v_mfma_f32_16x16x32_bf16 v[48:51], a[48:51], a[76:79], v[48:51]
    ds_read_b64_tr_b16 a[18:19], v100 offset:9216
    v_mfma_f32_16x16x32_bf16 v[52:55], a[48:51], a[80:83], v[52:55]
    ds_read_b64_tr_b16 a[20:21], v101 offset:8192
    v_mfma_f32_16x16x32_bf16 v[56:59], a[48:51], a[84:87], v[56:59]
    ds_read_b64_tr_b16 a[22:23], v101 offset:9216
    v_mfma_f32_16x16x32_bf16 v[60:63], a[52:55], a[76:79], v[60:63]
    ds_read_b64_tr_b16 a[24:25], v102 offset:8192
    v_mfma_f32_16x16x32_bf16 v[64:67], a[52:55], a[80:83], v[64:67]
    ds_read_b64_tr_b16 a[26:27], v102 offset:9216
    v_mfma_f32_16x16x32_bf16 v[68:71], a[52:55], a[84:87], v[68:71]
    ds_read_b64_tr_b16 a[28:29], v103 offset:8192
    v_mfma_f32_16x16x32_bf16 v[72:75], a[56:59], a[76:79], v[72:75]
    ds_read_b64_tr_b16 a[30:31], v103 offset:9216
    v_mfma_f32_16x16x32_bf16 v[76:79], a[56:59], a[80:83], v[76:79]
    v_mfma_f32_16x16x32_bf16 v[80:83], a[56:59], a[84:87], v[80:83]
    v_mfma_f32_16x16x32_bf16 v[84:87], a[60:63], a[76:79], v[84:87]
    v_mfma_f32_16x16x32_bf16 v[88:91], a[60:63], a[80:83], v[88:91]
    v_mfma_f32_16x16x32_bf16 v[92:95], a[60:63], a[84:87], v[92:95]
    s_waitcnt lgkmcnt(0)
    s_barrier
    v_mfma_f32_16x16x32_bf16 v[0:3], a[0:3], a[64:67], v[0:3]
    ds_read_b128 a[76:79], v105 offset:49152
    v_mfma_f32_16x16x32_bf16 v[4:7], a[0:3], a[68:71], v[4:7]
    ds_read_b128 a[80:83], v105 offset:51200
    v_mfma_f32_16x16x32_bf16 v[8:11], a[0:3], a[72:75], v[8:11]
    ds_read_b128 a[84:87], v105 offset:53248
    v_mfma_f32_16x16x32_bf16 v[12:15], a[4:7], a[64:67], v[12:15]
    ds_read_b64_tr_b16 a[32:33], v96 offset:16384
    v_mfma_f32_16x16x32_bf16 v[16:19], a[4:7], a[68:71], v[16:19]
    ds_read_b64_tr_b16 a[34:35], v96 offset:17408
    v_mfma_f32_16x16x32_bf16 v[20:23], a[4:7], a[72:75], v[20:23]
    ds_read_b64_tr_b16 a[36:37], v97 offset:16384
    v_mfma_f32_16x16x32_bf16 v[24:27], a[8:11], a[64:67], v[24:27]
    ds_read_b64_tr_b16 a[38:39], v97 offset:17408
    v_mfma_f32_16x16x32_bf16 v[28:31], a[8:11], a[68:71], v[28:31]
    ds_read_b64_tr_b16 a[40:41], v98 offset:16384
    v_mfma_f32_16x16x32_bf16 v[32:35], a[8:11], a[72:75], v[32:35]
    ds_read_b64_tr_b16 a[42:43], v98 offset:17408
    v_mfma_f32_16x16x32_bf16 v[36:39], a[12:15], a[64:67], v[36:39]
    ds_read_b64_tr_b16 a[44:45], v99 offset:16384
    v_mfma_f32_16x16x32_bf16 v[40:43], a[12:15], a[68:71], v[40:43]
    ds_read_b64_tr_b16 a[46:47], v99 offset:17408
    v_mfma_f32_16x16x32_bf16 v[44:47], a[12:15], a[72:75], v[44:47]
    ds_read_b64_tr_b16 a[48:49], v100 offset:16384
    v_mfma_f32_16x16x32_bf16 v[48:51], a[16:19], a[64:67], v[48:51]
    ds_read_b64_tr_b16 a[50:51], v100 offset:17408
    v_mfma_f32_16x16x32_bf16 v[52:55], a[16:19], a[68:71], v[52:55]
    ds_read_b64_tr_b16 a[52:53], v101 offset:16384
    v_mfma_f32_16x16x32_bf16 v[56:59], a[16:19], a[72:75], v[56:59]
    ds_read_b64_tr_b16 a[54:55], v101 offset:17408
    v_mfma_f32_16x16x32_bf16 v[60:63], a[20:23], a[64:67], v[60:63]
    ds_read_b64_tr_b16 a[56:57], v102 offset:16384
    v_mfma_f32_16x16x32_bf16 v[64:67], a[20:23], a[68:71], v[64:67]
    ds_read_b64_tr_b16 a[58:59], v102 offset:17408
    v_mfma_f32_16x16x32_bf16 v[68:71], a[20:23], a[72:75], v[68:71]
    ds_read_b64_tr_b16 a[60:61], v103 offset:16384
    v_mfma_f32_16x16x32_bf16 v[72:75], a[24:27], a[64:67], v[72:75]
    ds_read_b64_tr_b16 a[62:63], v103 offset:17408
    v_mfma_f32_16x16x32_bf16 v[76:79], a[24:27], a[68:71], v[76:79]
    v_mfma_f32_16x16x32_bf16 v[80:83], a[24:27], a[72:75], v[80:83]
    v_mfma_f32_16x16x32_bf16 v[84:87], a[28:31], a[64:67], v[84:87]
    v_mfma_f32_16x16x32_bf16 v[88:91], a[28:31], a[68:71], v[88:91]
    v_mfma_f32_16x16x32_bf16 v[92:95], a[28:31], a[72:75], v[92:95]
    s_waitcnt lgkmcnt(0)
    s_barrier
    v_mfma_f32_16x16x32_bf16 v[0:3], a[32:35], a[76:79], v[0:3]
    ds_read_b128 a[64:67], v104 offset:0
    v_mfma_f32_16x16x32_bf16 v[4:7], a[32:35], a[80:83], v[4:7]
    ds_read_b128 a[68:71], v104 offset:2048
    v_mfma_f32_16x16x32_bf16 v[8:11], a[32:35], a[84:87], v[8:11]
    ds_read_b128 a[72:75], v104 offset:4096
    v_mfma_f32_16x16x32_bf16 v[12:15], a[36:39], a[76:79], v[12:15]
    ds_read_b64_tr_b16 a[0:1], v96 offset:24576
    v_mfma_f32_16x16x32_bf16 v[16:19], a[36:39], a[80:83], v[16:19]
    ds_read_b64_tr_b16 a[2:3], v96 offset:25600
    v_mfma_f32_16x16x32_bf16 v[20:23], a[36:39], a[84:87], v[20:23]
    ds_read_b64_tr_b16 a[4:5], v97 offset:24576
    v_mfma_f32_16x16x32_bf16 v[24:27], a[40:43], a[76:79], v[24:27]
    ds_read_b64_tr_b16 a[6:7], v97 offset:25600
    v_mfma_f32_16x16x32_bf16 v[28:31], a[40:43], a[80:83], v[28:31]
    ds_read_b64_tr_b16 a[8:9], v98 offset:24576
    v_mfma_f32_16x16x32_bf16 v[32:35], a[40:43], a[84:87], v[32:35]
    ds_read_b64_tr_b16 a[10:11], v98 offset:25600
    v_mfma_f32_16x16x32_bf16 v[36:39], a[44:47], a[76:79], v[36:39]
    ds_read_b64_tr_b16 a[12:13], v99 offset:24576
    v_mfma_f32_16x16x32_bf16 v[40:43], a[44:47], a[80:83], v[40:43]
    ds_read_b64_tr_b16 a[14:15], v99 offset:25600
    v_mfma_f32_16x16x32_bf16 v[44:47], a[44:47], a[84:87], v[44:47]
    ds_read_b64_tr_b16 a[16:17], v100 offset:24576
    v_mfma_f32_16x16x32_bf16 v[48:51], a[48:51], a[76:79], v[48:51]
    ds_read_b64_tr_b16 a[18:19], v100 offset:25600
    v_mfma_f32_16x16x32_bf16 v[52:55], a[48:51], a[80:83], v[52:55]
    ds_read_b64_tr_b16 a[20:21], v101 offset:24576
    v_mfma_f32_16x16x32_bf16 v[56:59], a[48:51], a[84:87], v[56:59]
    ds_read_b64_tr_b16 a[22:23], v101 offset:25600
    v_mfma_f32_16x16x32_bf16 v[60:63], a[52:55], a[76:79], v[60:63]
    ds_read_b64_tr_b16 a[24:25], v102 offset:24576
    v_mfma_f32_16x16x32_bf16 v[64:67], a[52:55], a[80:83], v[64:67]
    ds_read_b64_tr_b16 a[26:27], v102 offset:25600
    v_mfma_f32_16x16x32_bf16 v[68:71], a[52:55], a[84:87], v[68:71]
    ds_read_b64_tr_b16 a[28:29], v103 offset:24576
    v_mfma_f32_16x16x32_bf16 v[72:75], a[56:59], a[76:79], v[72:75]
    ds_read_b64_tr_b16 a[30:31], v103 offset:25600
    v_mfma_f32_16x16x32_bf16 v[76:79], a[56:59], a[80:83], v[76:79]
    v_mfma_f32_16x16x32_bf16 v[80:83], a[56:59], a[84:87], v[80:83]
    v_mfma_f32_16x16x32_bf16 v[84:87], a[60:63], a[76:79], v[84:87]
    v_mfma_f32_16x16x32_bf16 v[88:91], a[60:63], a[80:83], v[88:91]
    v_mfma_f32_16x16x32_bf16 v[92:95], a[60:63], a[84:87], v[92:95]
    s_waitcnt lgkmcnt(0)
    s_barrier
    v_mfma_f32_16x16x32_bf16 v[0:3], a[0:3], a[64:67], v[0:3]
    ds_read_b128 a[76:79], v105 offset:0
    v_mfma_f32_16x16x32_bf16 v[4:7], a[0:3], a[68:71], v[4:7]
    ds_read_b128 a[80:83], v105 offset:2048
    v_mfma_f32_16x16x32_bf16 v[8:11], a[0:3], a[72:75], v[8:11]
    ds_read_b128 a[84:87], v105 offset:4096
    v_mfma_f32_16x16x32_bf16 v[12:15], a[4:7], a[64:67], v[12:15]
    ds_read_b64_tr_b16 a[32:33], v96 offset:32768
    v_mfma_f32_16x16x32_bf16 v[16:19], a[4:7], a[68:71], v[16:19]
    ds_read_b64_tr_b16 a[34:35], v96 offset:33792
    v_mfma_f32_16x16x32_bf16 v[20:23], a[4:7], a[72:75], v[20:23]
    ds_read_b64_tr_b16 a[36:37], v97 offset:32768
    v_mfma_f32_16x16x32_bf16 v[24:27], a[8:11], a[64:67], v[24:27]
    ds_read_b64_tr_b16 a[38:39], v97 offset:33792
    v_mfma_f32_16x16x32_bf16 v[28:31], a[8:11], a[68:71], v[28:31]
    ds_read_b64_tr_b16 a[40:41], v98 offset:32768
    v_mfma_f32_16x16x32_bf16 v[32:35], a[8:11], a[72:75], v[32:35]
    ds_read_b64_tr_b16 a[42:43], v98 offset:33792
    v_mfma_f32_16x16x32_bf16 v[36:39], a[12:15], a[64:67], v[36:39]
    ds_read_b64_tr_b16 a[44:45], v99 offset:32768
    v_mfma_f32_16x16x32_bf16 v[40:43], a[12:15], a[68:71], v[40:43]
    ds_read_b64_tr_b16 a[46:47], v99 offset:33792
    v_mfma_f32_16x16x32_bf16 v[44:47], a[12:15], a[72:75], v[44:47]
    ds_read_b64_tr_b16 a[48:49], v100 offset:32768
    v_mfma_f32_16x16x32_bf16 v[48:51], a[16:19], a[64:67], v[48:51]
    ds_read_b64_tr_b16 a[50:51], v100 offset:33792
    v_mfma_f32_16x16x32_bf16 v[52:55], a[16:19], a[68:71], v[52:55]
    ds_read_b64_tr_b16 a[52:53], v101 offset:32768
    v_mfma_f32_16x16x32_bf16 v[56:59], a[16:19], a[72:75], v[56:59]
    ds_read_b64_tr_b16 a[54:55], v101 offset:33792
    v_mfma_f32_16x16x32_bf16 v[60:63], a[20:23], a[64:67], v[60:63]
    ds_read_b64_tr_b16 a[56:57], v102 offset:32768
    v_mfma_f32_16x16x32_bf16 v[64:67], a[20:23], a[68:71], v[64:67]
    ds_read_b64_tr_b16 a[58:59], v102 offset:33792
    v_mfma_f32_16x16x32_bf16 v[68:71], a[20:23], a[72:75], v[68:71]
    ds_read_b64_tr_b16 a[60:61], v103 offset:32768
    v_mfma_f32_16x16x32_bf16 v[72:75], a[24:27], a[64:67], v[72:75]
    ds_read_b64_tr_b16 a[62:63], v103 offset:33792
    v_mfma_f32_16x16x32_bf16 v[76:79], a[24:27], a[68:71], v[76:79]
    v_mfma_f32_16x16x32_bf16 v[80:83], a[24:27], a[72:75], v[80:83]
    v_mfma_f32_16x16x32_bf16 v[84:87], a[28:31], a[64:67], v[84:87]
    v_mfma_f32_16x16x32_bf16 v[88:91], a[28:31], a[68:71], v[88:91]
    v_mfma_f32_16x16x32_bf16 v[92:95], a[28:31], a[72:75], v[92:95]
    s_waitcnt lgkmcnt(0)
    v_and_b32 v113, 1, v109
    v_lshlrev_b32 v113, 3, v113
    v_xor_b32 v120, v113, v106
    v_xor_b32 v121, 8, v120
    v_xor_b32 v122, 64, v120
    v_xor_b32 v123, 64, v121
    v_xor_b32 v124, 128, v120
    v_xor_b32 v125, 128, v121
    v_xor_b32 v126, 192, v120
    v_xor_b32 v127, 192, v121
    v_mfma_f32_16x16x32_bf16 v[0:3], a[32:35], a[76:79], v[0:3]
    ds_read_b64 a[0:1], v120 offset:0
    ds_read_b64 a[2:3], v121 offset:0
    v_mfma_f32_16x16x32_bf16 v[4:7], a[32:35], a[80:83], v[4:7]
    ds_read_b64 a[4:5], v122 offset:0
    ds_read_b64 a[6:7], v123 offset:0
    v_mfma_f32_16x16x32_bf16 v[8:11], a[32:35], a[84:87], v[8:11]
    ds_read_b64 a[8:9], v124 offset:0
    ds_read_b64 a[10:11], v125 offset:0
    v_mfma_f32_16x16x32_bf16 v[12:15], a[36:39], a[76:79], v[12:15]
    ds_read_b64 a[12:13], v126 offset:0
    ds_read_b64 a[14:15], v127 offset:0
    v_mfma_f32_16x16x32_bf16 v[16:19], a[36:39], a[80:83], v[16:19]
    ds_read_b64 a[16:17], v120 offset:4096
    ds_read_b64 a[18:19], v121 offset:4096
    v_mfma_f32_16x16x32_bf16 v[20:23], a[36:39], a[84:87], v[20:23]
    ds_read_b64 a[20:21], v122 offset:4096
    ds_read_b64 a[22:23], v123 offset:4096
    v_mfma_f32_16x16x32_bf16 v[24:27], a[40:43], a[76:79], v[24:27]
    ds_read_b64 a[24:25], v124 offset:4096
    ds_read_b64 a[26:27], v125 offset:4096
    v_mfma_f32_16x16x32_bf16 v[28:31], a[40:43], a[80:83], v[28:31]
    ds_read_b64 a[28:29], v126 offset:4096
    ds_read_b64 a[30:31], v127 offset:4096
    v_mfma_f32_16x16x32_bf16 v[32:35], a[40:43], a[84:87], v[32:35]
    v_mfma_f32_16x16x32_bf16 v[36:39], a[44:47], a[76:79], v[36:39]
    v_cvt_pk_bf16_f32 v0, v0, v1
    v_cvt_pk_bf16_f32 v1, v2, v3
    v_mfma_f32_16x16x32_bf16 v[40:43], a[44:47], a[80:83], v[40:43]
    v_cvt_pk_bf16_f32 v2, v12, v13
    v_cvt_pk_bf16_f32 v3, v14, v15
    v_mfma_f32_16x16x32_bf16 v[44:47], a[44:47], a[84:87], v[44:47]
    v_cvt_pk_bf16_f32 v4, v4, v5
    v_cvt_pk_bf16_f32 v5, v6, v7
    v_mfma_f32_16x16x32_bf16 v[48:51], a[48:51], a[76:79], v[48:51]
    ds_read_b64 a[32:33], v120 offset:8192
    v_cvt_pk_bf16_f32 v6, v16, v17
    v_cvt_pk_bf16_f32 v7, v18, v19
    v_mfma_f32_16x16x32_bf16 v[52:55], a[48:51], a[80:83], v[52:55]
    ds_read_b64 a[34:35], v121 offset:8192
    v_cvt_pk_bf16_f32 v8, v8, v9
    v_cvt_pk_bf16_f32 v9, v10, v11
    v_mfma_f32_16x16x32_bf16 v[56:59], a[48:51], a[84:87], v[56:59]
    ds_read_b64 a[36:37], v122 offset:8192
    v_cvt_pk_bf16_f32 v10, v20, v21
    v_cvt_pk_bf16_f32 v11, v22, v23
    v_mfma_f32_16x16x32_bf16 v[60:63], a[52:55], a[76:79], v[60:63]
    ds_read_b64 a[38:39], v123 offset:8192
    v_cvt_pk_bf16_f32 v24, v24, v25
    v_cvt_pk_bf16_f32 v25, v26, v27
    v_mfma_f32_16x16x32_bf16 v[64:67], a[52:55], a[80:83], v[64:67]
    ds_read_b64 a[40:41], v124 offset:8192
    v_cvt_pk_bf16_f32 v26, v36, v37
    v_cvt_pk_bf16_f32 v27, v38, v39
    v_mfma_f32_16x16x32_bf16 v[68:71], a[52:55], a[84:87], v[68:71]
    ds_read_b64 a[42:43], v125 offset:8192
    v_cvt_pk_bf16_f32 v28, v28, v29
    v_cvt_pk_bf16_f32 v29, v30, v31
    v_mfma_f32_16x16x32_bf16 v[72:75], a[56:59], a[76:79], v[72:75]
    ds_read_b64 a[44:45], v126 offset:8192
    v_cvt_pk_bf16_f32 v30, v40, v41
    v_cvt_pk_bf16_f32 v31, v42, v43
    v_mfma_f32_16x16x32_bf16 v[76:79], a[56:59], a[80:83], v[76:79]
    ds_read_b64 a[46:47], v127 offset:8192
    v_cvt_pk_bf16_f32 v32, v32, v33
    v_cvt_pk_bf16_f32 v33, v34, v35
    v_mfma_f32_16x16x32_bf16 v[80:83], a[56:59], a[84:87], v[80:83]
    v_cvt_pk_bf16_f32 v34, v44, v45
    v_cvt_pk_bf16_f32 v35, v46, v47
    v_mfma_f32_16x16x32_bf16 v[84:87], a[60:63], a[76:79], v[84:87]
    v_cvt_pk_bf16_f32 v48, v48, v49
    v_cvt_pk_bf16_f32 v49, v50, v51
    v_mfma_f32_16x16x32_bf16 v[88:91], a[60:63], a[80:83], v[88:91]
    v_cvt_pk_bf16_f32 v50, v60, v61
    v_cvt_pk_bf16_f32 v51, v62, v63
    v_mfma_f32_16x16x32_bf16 v[92:95], a[60:63], a[84:87], v[92:95]
    v_cvt_pk_bf16_f32 v52, v52, v53
    v_cvt_pk_bf16_f32 v53, v54, v55
    v_cvt_pk_bf16_f32 v54, v64, v65
    v_cvt_pk_bf16_f32 v55, v66, v67
    v_cvt_pk_bf16_f32 v56, v56, v57
    v_cvt_pk_bf16_f32 v57, v58, v59
    v_cvt_pk_bf16_f32 v58, v68, v69
    v_cvt_pk_bf16_f32 v59, v70, v71
    s_mov_b32 s52, 0x3e0293ee
    v_lshlrev_b32 v112, 2, v109
    v_add_u32 v112, v112, v110
    v_and_b32 v113, 7, v112
    v_lshlrev_b32 v112, 8, v112
    v_lshrrev_b32 v114, 1, v111
    v_lshlrev_b32 v114, 4, v114
    v_add_u32 v112, v112, v114
    v_and_b32 v114, 1, v111
    v_lshlrev_b32 v114, 3, v114
    v_add_u32 v118, v112, v114
    v_mov_b32 v119, v113
    s_add_u32 s40, s54, 73728
    v_add_u32 v112, s40, v118
    v_cvt_pk_bf16_f32 v72, v72, v73
    v_cvt_pk_bf16_f32 v73, v74, v75
    v_cvt_pk_bf16_f32 v74, v84, v85
    v_cvt_pk_bf16_f32 v75, v86, v87
    v_cvt_pk_bf16_f32 v76, v76, v77
    v_cvt_pk_bf16_f32 v77, v78, v79
    v_cvt_pk_bf16_f32 v78, v88, v89
    v_cvt_pk_bf16_f32 v79, v90, v91
    v_cvt_pk_bf16_f32 v80, v80, v81
    v_cvt_pk_bf16_f32 v81, v82, v83
    v_cvt_pk_bf16_f32 v82, v92, v93
    v_cvt_pk_bf16_f32 v83, v94, v95
    s_waitcnt lgkmcnt(0)
    v_mfma_f32_16x16x32_bf16 v[12:15], a[0:3], v[0:3], 0
    v_mfma_f32_16x16x32_bf16 v[12:15], a[4:7], v[24:27], v[12:15]
    v_mfma_f32_16x16x32_bf16 v[12:15], a[8:11], v[48:51], v[12:15]
    v_mfma_f32_16x16x32_bf16 v[12:15], a[12:15], v[72:75], v[12:15]
    v_mfma_f32_16x16x32_bf16 v[16:19], a[16:19], v[0:3], 0
    v_mfma_f32_16x16x32_bf16 v[16:19], a[20:23], v[24:27], v[16:19]
    v_mfma_f32_16x16x32_bf16 v[16:19], a[24:27], v[48:51], v[16:19]
    v_mfma_f32_16x16x32_bf16 v[16:19], a[28:31], v[72:75], v[16:19]
    v_mfma_f32_16x16x32_bf16 v[20:23], a[32:35], v[0:3], 0
    v_mfma_f32_16x16x32_bf16 v[20:23], a[36:39], v[24:27], v[20:23]
    v_mfma_f32_16x16x32_bf16 v[20:23], a[40:43], v[48:51], v[20:23]
    v_mfma_f32_16x16x32_bf16 v[20:23], a[44:47], v[72:75], v[20:23]
    v_mfma_f32_16x16x32_bf16 v[36:39], a[0:3], v[4:7], 0
    v_xor_b32 v114, 0, v113
    v_lshlrev_b32 v114, 5, v114
    v_mfma_f32_16x16x32_bf16 v[36:39], a[4:7], v[28:31], v[36:39]
    v_add_u32 v96, v112, v114
    v_xor_b32 v114, 1, v113
    v_mfma_f32_16x16x32_bf16 v[36:39], a[8:11], v[52:55], v[36:39]
    v_lshlrev_b32 v114, 5, v114
    v_add_u32 v97, v112, v114
    v_mfma_f32_16x16x32_bf16 v[36:39], a[12:15], v[76:79], v[36:39]
    v_xor_b32 v114, 2, v113
    v_lshlrev_b32 v114, 5, v114
    v_mfma_f32_16x16x32_bf16 v[40:43], a[16:19], v[4:7], 0
    v_add_u32 v98, v112, v114
    v_xor_b32 v114, 3, v113
    v_mfma_f32_16x16x32_bf16 v[40:43], a[20:23], v[28:31], v[40:43]
    v_lshlrev_b32 v114, 5, v114
    v_add_u32 v99, v112, v114
    v_mfma_f32_16x16x32_bf16 v[40:43], a[24:27], v[52:55], v[40:43]
    v_xor_b32 v114, 4, v113
    v_lshlrev_b32 v114, 5, v114
    v_mfma_f32_16x16x32_bf16 v[40:43], a[28:31], v[76:79], v[40:43]
    v_add_u32 v100, v112, v114
    v_xor_b32 v114, 5, v113
    v_mfma_f32_16x16x32_bf16 v[44:47], a[32:35], v[4:7], 0
    v_lshlrev_b32 v114, 5, v114
    v_add_u32 v101, v112, v114
    v_mfma_f32_16x16x32_bf16 v[44:47], a[36:39], v[28:31], v[44:47]
    v_xor_b32 v114, 6, v113
    v_lshlrev_b32 v114, 5, v114
    v_mfma_f32_16x16x32_bf16 v[44:47], a[40:43], v[52:55], v[44:47]
    v_add_u32 v102, v112, v114
    v_xor_b32 v114, 7, v113
    v_mfma_f32_16x16x32_bf16 v[44:47], a[44:47], v[76:79], v[44:47]
    v_lshlrev_b32 v114, 5, v114
    v_add_u32 v103, v112, v114
    v_max3_f32 v120, v12, v13, v14
    v_max3_f32 v121, v15, v16, v17
    v_max3_f32 v120, v120, v18, v19
    v_mfma_f32_16x16x32_bf16 v[60:63], a[0:3], v[8:11], 0
    v_max3_f32 v121, v121, v20, v21
    v_max3_f32 v120, v120, v22, v23
    v_max_f32 v120, v120, v121
    v_mfma_f32_16x16x32_bf16 v[60:63], a[4:7], v[32:35], v[60:63]
    v_mov_b32 v121, v120
    s_nop 1
    v_permlane16_swap_b32 v120, v121
    v_mfma_f32_16x16x32_bf16 v[60:63], a[8:11], v[56:59], v[60:63]
    v_max_f32 v120, v120, v121
    v_mov_b32 v121, v120
    s_nop 1
    v_mfma_f32_16x16x32_bf16 v[60:63], a[12:15], v[80:83], v[60:63]
    v_permlane32_swap_b32 v120, v121
    v_max_f32 v120, v120, v121
    v_mul_f32 v120, s52, v120
    v_mfma_f32_16x16x32_bf16 v[64:67], a[16:19], v[8:11], 0
    v_fma_f32 v12, v12, s52, -v120
    v_fma_f32 v13, v13, s52, -v120
    v_fma_f32 v14, v14, s52, -v120
    v_mfma_f32_16x16x32_bf16 v[64:67], a[20:23], v[32:35], v[64:67]
    v_fma_f32 v15, v15, s52, -v120
    v_fma_f32 v16, v16, s52, -v120
    v_fma_f32 v17, v17, s52, -v120
    v_mfma_f32_16x16x32_bf16 v[64:67], a[24:27], v[56:59], v[64:67]
    v_fma_f32 v18, v18, s52, -v120
    v_fma_f32 v19, v19, s52, -v120
    v_fma_f32 v20, v20, s52, -v120
    v_mfma_f32_16x16x32_bf16 v[64:67], a[28:31], v[80:83], v[64:67]
    v_fma_f32 v21, v21, s52, -v120
    v_fma_f32 v22, v22, s52, -v120
    v_fma_f32 v23, v23, s52, -v120
    v_mfma_f32_16x16x32_bf16 v[68:71], a[32:35], v[8:11], 0
    v_exp_f32 v12, v12
    v_exp_f32 v13, v13
    v_exp_f32 v14, v14
    v_mfma_f32_16x16x32_bf16 v[68:71], a[36:39], v[32:35], v[68:71]
    v_exp_f32 v15, v15
    v_exp_f32 v16, v16
    v_exp_f32 v17, v17
    v_mfma_f32_16x16x32_bf16 v[68:71], a[40:43], v[56:59], v[68:71]
    v_exp_f32 v18, v18
    v_exp_f32 v19, v19
    v_exp_f32 v20, v20
    v_mfma_f32_16x16x32_bf16 v[68:71], a[44:47], v[80:83], v[68:71]
    v_exp_f32 v21, v21
    v_exp_f32 v22, v22
    v_exp_f32 v23, v23
    s_nop 0
    v_add_f32 v122, v12, v13
    v_add_f32 v123, v14, v15
    v_add_f32 v122, v122, v16
    v_add_f32 v123, v123, v17
    v_add_f32 v122, v122, v18
    v_add_f32 v123, v123, v19
    v_add_f32 v122, v122, v20
    v_add_f32 v123, v123, v21
    v_add_f32 v122, v122, v22
    v_add_f32 v123, v123, v23
    v_add_f32 v122, v122, v123
    v_mov_b32 v123, v122
    s_nop 1
    v_permlane16_swap_b32 v122, v123
    v_add_f32 v122, v122, v123
    v_mov_b32 v123, v122
    s_nop 1
    v_permlane32_swap_b32 v122, v123
    v_add_f32 v122, v122, v123
    v_rcp_f32 v122, v122
    s_nop 0
    v_mul_f32 v12, v12, v122
    v_mul_f32 v13, v13, v122
    v_mul_f32 v14, v14, v122
    v_mul_f32 v15, v15, v122
    v_mul_f32 v16, v16, v122
    v_mul_f32 v17, v17, v122
    v_mul_f32 v18, v18, v122
    v_mul_f32 v19, v19, v122
    v_mul_f32 v20, v20, v122
    v_mul_f32 v21, v21, v122
    v_mul_f32 v22, v22, v122
    v_mul_f32 v23, v23, v122
    v_cvt_pk_bf16_f32 v84, v12, v13
    v_cvt_pk_bf16_f32 v85, v14, v15
    v_cvt_pk_bf16_f32 v86, v16, v17
    v_cvt_pk_bf16_f32 v87, v18, v19
    v_cvt_pk_bf16_f32 v88, v20, v21
    v_cvt_pk_bf16_f32 v89, v22, v23
    v_max3_f32 v124, v36, v37, v38
    v_max3_f32 v125, v39, v40, v41
    v_max3_f32 v124, v124, v42, v43
    v_max3_f32 v125, v125, v44, v45
    v_max3_f32 v124, v124, v46, v47
    v_max_f32 v124, v124, v125
    v_mov_b32 v125, v124
    s_nop 1
    v_permlane16_swap_b32 v124, v125
    v_max_f32 v124, v124, v125
    v_mov_b32 v125, v124
    s_nop 1
    v_permlane32_swap_b32 v124, v125
    v_max_f32 v124, v124, v125
    v_mul_f32 v124, s52, v124
    v_fma_f32 v36, v36, s52, -v124
    v_fma_f32 v37, v37, s52, -v124
    v_fma_f32 v38, v38, s52, -v124
    v_fma_f32 v39, v39, s52, -v124
    v_fma_f32 v40, v40, s52, -v124
    v_fma_f32 v41, v41, s52, -v124
    v_fma_f32 v42, v42, s52, -v124
    v_fma_f32 v43, v43, s52, -v124
    v_fma_f32 v44, v44, s52, -v124
    v_fma_f32 v45, v45, s52, -v124
    v_fma_f32 v46, v46, s52, -v124
    v_fma_f32 v47, v47, s52, -v124
    v_exp_f32 v36, v36
    v_exp_f32 v37, v37
    v_exp_f32 v38, v38
    v_exp_f32 v39, v39
    v_exp_f32 v40, v40
    v_exp_f32 v41, v41
    v_exp_f32 v42, v42
    v_exp_f32 v43, v43
    v_exp_f32 v44, v44
    v_exp_f32 v45, v45
    v_exp_f32 v46, v46
    v_exp_f32 v47, v47
    s_nop 0
    v_add_f32 v126, v36, v37
    v_add_f32 v127, v38, v39
    v_add_f32 v126, v126, v40
    v_add_f32 v127, v127, v41
    v_add_f32 v126, v126, v42
    v_add_f32 v127, v127, v43
    v_add_f32 v126, v126, v44
    v_add_f32 v127, v127, v45
    v_add_f32 v126, v126, v46
    v_add_f32 v127, v127, v47
    v_add_f32 v126, v126, v127
    v_mov_b32 v127, v126
    s_nop 1
    v_permlane16_swap_b32 v126, v127
    v_add_f32 v126, v126, v127
    v_mov_b32 v127, v126
    s_nop 1
    v_permlane32_swap_b32 v126, v127
    v_add_f32 v126, v126, v127
    v_rcp_f32 v126, v126
    s_nop 0
    v_mul_f32 v36, v36, v126
    v_mul_f32 v37, v37, v126
    v_mul_f32 v38, v38, v126
    v_mul_f32 v39, v39, v126
    v_mul_f32 v40, v40, v126
    v_mul_f32 v41, v41, v126
    v_mul_f32 v42, v42, v126
    v_mul_f32 v43, v43, v126
    v_mul_f32 v44, v44, v126
    v_mul_f32 v45, v45, v126
    v_mul_f32 v46, v46, v126
    v_mul_f32 v47, v47, v126
    v_cvt_pk_bf16_f32 v90, v36, v37
    v_cvt_pk_bf16_f32 v91, v38, v39
    v_cvt_pk_bf16_f32 v92, v40, v41
    v_cvt_pk_bf16_f32 v93, v42, v43
    v_cvt_pk_bf16_f32 v94, v44, v45
    v_cvt_pk_bf16_f32 v95, v46, v47
    v_max3_f32 v128, v60, v61, v62
    v_max3_f32 v129, v63, v64, v65
    v_max3_f32 v128, v128, v66, v67
    v_max3_f32 v129, v129, v68, v69
    v_max3_f32 v128, v128, v70, v71
    v_max_f32 v128, v128, v129
    v_mov_b32 v129, v128
    s_nop 1
    v_permlane16_swap_b32 v128, v129
    v_max_f32 v128, v128, v129
    v_mov_b32 v129, v128
    s_nop 1
    v_permlane32_swap_b32 v128, v129
    v_max_f32 v128, v128, v129
    v_mul_f32 v128, s52, v128
    v_fma_f32 v60, v60, s52, -v128
    v_fma_f32 v61, v61, s52, -v128
    v_fma_f32 v62, v62, s52, -v128
    v_fma_f32 v63, v63, s52, -v128
    v_fma_f32 v64, v64, s52, -v128
    v_fma_f32 v65, v65, s52, -v128
    v_fma_f32 v66, v66, s52, -v128
    v_fma_f32 v67, v67, s52, -v128
    v_fma_f32 v68, v68, s52, -v128
    v_fma_f32 v69, v69, s52, -v128
    v_fma_f32 v70, v70, s52, -v128
    v_fma_f32 v71, v71, s52, -v128
    v_exp_f32 v60, v60
    v_exp_f32 v61, v61
    v_exp_f32 v62, v62
    v_exp_f32 v63, v63
    v_exp_f32 v64, v64
    v_exp_f32 v65, v65
    v_exp_f32 v66, v66
    v_exp_f32 v67, v67
    v_exp_f32 v68, v68
    v_exp_f32 v69, v69
    v_exp_f32 v70, v70
    v_exp_f32 v71, v71
    s_nop 0
    v_add_f32 v130, v60, v61
    v_add_f32 v131, v62, v63
    v_add_f32 v130, v130, v64
    v_add_f32 v131, v131, v65
    v_add_f32 v130, v130, v66
    v_add_f32 v131, v131, v67
    v_add_f32 v130, v130, v68
    v_add_f32 v131, v131, v69
    v_add_f32 v130, v130, v70
    v_add_f32 v131, v131, v71
    v_add_f32 v130, v130, v131
    v_mov_b32 v131, v130
    s_nop 1
    v_permlane16_swap_b32 v130, v131
    v_add_f32 v130, v130, v131
    v_mov_b32 v131, v130
    s_nop 1
    v_permlane32_swap_b32 v130, v131
    v_add_f32 v130, v130, v131
    v_rcp_f32 v130, v130
    s_nop 0
    v_mul_f32 v60, v60, v130
    v_mul_f32 v61, v61, v130
    v_mul_f32 v62, v62, v130
    v_mul_f32 v63, v63, v130
    v_mul_f32 v64, v64, v130
    v_mul_f32 v65, v65, v130
    v_mul_f32 v66, v66, v130
    v_mul_f32 v67, v67, v130
    v_mul_f32 v68, v68, v130
    v_mul_f32 v69, v69, v130
    v_mul_f32 v70, v70, v130
    v_mul_f32 v71, v71, v130
    v_cvt_pk_bf16_f32 v0, v60, v61
    v_cvt_pk_bf16_f32 v1, v62, v63
    v_cvt_pk_bf16_f32 v2, v64, v65
    v_cvt_pk_bf16_f32 v3, v66, v67
    v_cvt_pk_bf16_f32 v4, v68, v69
    v_cvt_pk_bf16_f32 v5, v70, v71
    s_barrier
    ds_read_b64_tr_b16 a[48:49], v96 offset:0
    ds_read_b64_tr_b16 a[50:51], v96 offset:24576
    ds_read_b64_tr_b16 a[52:53], v96 offset:49152
    ds_read_b64_tr_b16 a[54:55], v97 offset:0
    ds_read_b64_tr_b16 a[56:57], v97 offset:24576
    ds_read_b64_tr_b16 a[58:59], v97 offset:49152
    ds_read_b64_tr_b16 a[60:61], v98 offset:0
    ds_read_b64_tr_b16 a[62:63], v98 offset:24576
    ds_read_b64_tr_b16 a[64:65], v98 offset:49152
    ds_read_b64_tr_b16 a[66:67], v99 offset:0
    ds_read_b64_tr_b16 a[68:69], v99 offset:24576
    ds_read_b64_tr_b16 a[70:71], v99 offset:49152
    s_waitcnt lgkmcnt(6)
    v_mfma_f32_16x16x32_bf16 v[36:39], a[48:51], v[84:87], 0
    v_mfma_f32_16x16x32_bf16 v[40:43], a[48:51], v[90:93], 0
    v_mfma_f32_16x16x32_bf16 v[44:47], a[48:51], v[0:3], 0
    v_mfma_f32_16x16x32_bf16 v[48:51], a[54:57], v[84:87], 0
    v_mfma_f32_16x16x32_bf16 v[52:55], a[54:57], v[90:93], 0
    v_mfma_f32_16x16x32_bf16 v[56:59], a[54:57], v[0:3], 0
    ds_read_b64_tr_b16 a[72:73], v100 offset:0
    ds_read_b64_tr_b16 a[74:75], v100 offset:24576
    ds_read_b64_tr_b16 a[76:77], v100 offset:49152
    ds_read_b64_tr_b16 a[78:79], v101 offset:0
    ds_read_b64_tr_b16 a[80:81], v101 offset:24576
    ds_read_b64_tr_b16 a[82:83], v101 offset:49152
    s_nop 5
    v_mfma_f32_16x16x16_bf16 v[36:39], a[52:53], v[88:89], v[36:39]
    v_mfma_f32_16x16x16_bf16 v[40:43], a[52:53], v[94:95], v[40:43]
    v_mfma_f32_16x16x16_bf16 v[44:47], a[52:53], v[4:5], v[44:47]
    v_mfma_f32_16x16x16_bf16 v[48:51], a[58:59], v[88:89], v[48:51]
    v_mfma_f32_16x16x16_bf16 v[52:55], a[58:59], v[94:95], v[52:55]
    v_mfma_f32_16x16x16_bf16 v[56:59], a[58:59], v[4:5], v[56:59]
    s_waitcnt lgkmcnt(6)
    v_mfma_f32_16x16x32_bf16 v[60:63], a[60:63], v[84:87], 0
    v_mfma_f32_16x16x32_bf16 v[64:67], a[60:63], v[90:93], 0
    v_mfma_f32_16x16x32_bf16 v[68:71], a[60:63], v[0:3], 0
    v_mfma_f32_16x16x32_bf16 v[72:75], a[66:69], v[84:87], 0
    v_mfma_f32_16x16x32_bf16 v[76:79], a[66:69], v[90:93], 0
    v_mfma_f32_16x16x32_bf16 v[80:83], a[66:69], v[0:3], 0
    ds_read_b64_tr_b16 a[48:49], v102 offset:0
    ds_read_b64_tr_b16 a[50:51], v102 offset:24576
    ds_read_b64_tr_b16 a[52:53], v102 offset:49152
    ds_read_b64_tr_b16 a[54:55], v103 offset:0
    ds_read_b64_tr_b16 a[56:57], v103 offset:24576
    ds_read_b64_tr_b16 a[58:59], v103 offset:49152
    v_cvt_pk_bf16_f32 v12, v36, v37
    v_cvt_pk_bf16_f32 v13, v38, v39
    v_cvt_pk_bf16_f32 v14, v48, v49
    v_cvt_pk_bf16_f32 v15, v50, v51
    buffer_store_dwordx4 v[12:15], v107, s[24:27], 0 offen offset:0 sc1
    v_cvt_pk_bf16_f32 v16, v40, v41
    v_cvt_pk_bf16_f32 v17, v42, v43
    v_cvt_pk_bf16_f32 v18, v52, v53
    v_cvt_pk_bf16_f32 v19, v54, v55
    buffer_store_dwordx4 v[16:19], v107, s[24:27], s47 offen offset:0 sc1
    v_cvt_pk_bf16_f32 v20, v44, v45
    v_cvt_pk_bf16_f32 v21, v46, v47
    v_cvt_pk_bf16_f32 v22, v56, v57
    v_cvt_pk_bf16_f32 v23, v58, v59
    buffer_store_dwordx4 v[20:23], v107, s[24:27], s48 offen offset:0 sc1
    v_mfma_f32_16x16x16_bf16 v[60:63], a[64:65], v[88:89], v[60:63]
    v_mfma_f32_16x16x16_bf16 v[64:67], a[64:65], v[94:95], v[64:67]
    v_mfma_f32_16x16x16_bf16 v[68:71], a[64:65], v[4:5], v[68:71]
    v_mfma_f32_16x16x16_bf16 v[72:75], a[70:71], v[88:89], v[72:75]
    v_mfma_f32_16x16x16_bf16 v[76:79], a[70:71], v[94:95], v[76:79]
    v_mfma_f32_16x16x16_bf16 v[80:83], a[70:71], v[4:5], v[80:83]
    s_waitcnt lgkmcnt(6)
    v_mfma_f32_16x16x32_bf16 v[36:39], a[72:75], v[84:87], 0
    v_mfma_f32_16x16x32_bf16 v[40:43], a[72:75], v[90:93], 0
    v_mfma_f32_16x16x32_bf16 v[44:47], a[72:75], v[0:3], 0
    v_mfma_f32_16x16x32_bf16 v[48:51], a[78:81], v[84:87], 0
    v_mfma_f32_16x16x32_bf16 v[52:55], a[78:81], v[90:93], 0
    v_mfma_f32_16x16x32_bf16 v[56:59], a[78:81], v[0:3], 0
    v_cvt_pk_bf16_f32 v24, v60, v61
    v_cvt_pk_bf16_f32 v25, v62, v63
    v_cvt_pk_bf16_f32 v26, v72, v73
    v_cvt_pk_bf16_f32 v27, v74, v75
    buffer_store_dwordx4 v[24:27], v107, s[24:27], 0 offen offset:1024 sc1
    v_cvt_pk_bf16_f32 v28, v64, v65
    v_cvt_pk_bf16_f32 v29, v66, v67
    v_cvt_pk_bf16_f32 v30, v76, v77
    v_cvt_pk_bf16_f32 v31, v78, v79
    buffer_store_dwordx4 v[28:31], v107, s[24:27], s47 offen offset:1024 sc1
    v_cvt_pk_bf16_f32 v32, v68, v69
    v_cvt_pk_bf16_f32 v33, v70, v71
    v_cvt_pk_bf16_f32 v34, v80, v81
    v_cvt_pk_bf16_f32 v35, v82, v83
    buffer_store_dwordx4 v[32:35], v107, s[24:27], s48 offen offset:1024 sc1
    v_mfma_f32_16x16x16_bf16 v[36:39], a[76:77], v[88:89], v[36:39]
    v_mfma_f32_16x16x16_bf16 v[40:43], a[76:77], v[94:95], v[40:43]
    v_mfma_f32_16x16x16_bf16 v[44:47], a[76:77], v[4:5], v[44:47]
    v_mfma_f32_16x16x16_bf16 v[48:51], a[82:83], v[88:89], v[48:51]
    v_mfma_f32_16x16x16_bf16 v[52:55], a[82:83], v[94:95], v[52:55]
    v_mfma_f32_16x16x16_bf16 v[56:59], a[82:83], v[4:5], v[56:59]
    s_waitcnt lgkmcnt(0)
    v_mfma_f32_16x16x32_bf16 v[60:63], a[48:51], v[84:87], 0
    v_mfma_f32_16x16x32_bf16 v[64:67], a[48:51], v[90:93], 0
    v_mfma_f32_16x16x32_bf16 v[68:71], a[48:51], v[0:3], 0
    v_mfma_f32_16x16x32_bf16 v[72:75], a[54:57], v[84:87], 0
    v_mfma_f32_16x16x32_bf16 v[76:79], a[54:57], v[90:93], 0
    v_mfma_f32_16x16x32_bf16 v[80:83], a[54:57], v[0:3], 0
    v_cvt_pk_bf16_f32 v12, v36, v37
    v_cvt_pk_bf16_f32 v13, v38, v39
    v_cvt_pk_bf16_f32 v14, v48, v49
    v_cvt_pk_bf16_f32 v15, v50, v51
    buffer_store_dwordx4 v[12:15], v107, s[24:27], 0 offen offset:2048 sc1
    v_cvt_pk_bf16_f32 v16, v40, v41
    v_cvt_pk_bf16_f32 v17, v42, v43
    v_cvt_pk_bf16_f32 v18, v52, v53
    v_cvt_pk_bf16_f32 v19, v54, v55
    buffer_store_dwordx4 v[16:19], v107, s[24:27], s47 offen offset:2048 sc1
    v_cvt_pk_bf16_f32 v20, v44, v45
    v_cvt_pk_bf16_f32 v21, v46, v47
    v_cvt_pk_bf16_f32 v22, v56, v57
    v_cvt_pk_bf16_f32 v23, v58, v59
    buffer_store_dwordx4 v[20:23], v107, s[24:27], s48 offen offset:2048 sc1
    v_mfma_f32_16x16x16_bf16 v[60:63], a[52:53], v[88:89], v[60:63]
    v_mfma_f32_16x16x16_bf16 v[64:67], a[52:53], v[94:95], v[64:67]
    v_mfma_f32_16x16x16_bf16 v[68:71], a[52:53], v[4:5], v[68:71]
    v_mfma_f32_16x16x16_bf16 v[72:75], a[58:59], v[88:89], v[72:75]
    v_mfma_f32_16x16x16_bf16 v[76:79], a[58:59], v[94:95], v[76:79]
    v_mfma_f32_16x16x16_bf16 v[80:83], a[58:59], v[4:5], v[80:83]
    s_nop 7
    v_cvt_pk_bf16_f32 v24, v60, v61
    v_cvt_pk_bf16_f32 v25, v62, v63
    v_cvt_pk_bf16_f32 v26, v72, v73
    v_cvt_pk_bf16_f32 v27, v74, v75
    buffer_store_dwordx4 v[24:27], v107, s[24:27], 0 offen offset:3072 sc1
    v_cvt_pk_bf16_f32 v28, v64, v65
    v_cvt_pk_bf16_f32 v29, v66, v67
    v_cvt_pk_bf16_f32 v30, v76, v77
    v_cvt_pk_bf16_f32 v31, v78, v79
    buffer_store_dwordx4 v[28:31], v107, s[24:27], s47 offen offset:3072 sc1
    v_cvt_pk_bf16_f32 v32, v68, v69
    v_cvt_pk_bf16_f32 v33, v70, v71
    v_cvt_pk_bf16_f32 v34, v80, v81
    v_cvt_pk_bf16_f32 v35, v82, v83
    buffer_store_dwordx4 v[32:35], v107, s[24:27], s48 offen offset:3072 sc1
    s_lshr_b32 s40, s38, 1
    s_lshl_b32 s40, s40, 2
    v_xor_b32 v113, s40, v119
    v_xor_b32 v114, 0, v113
    v_lshlrev_b32 v114, 5, v114
    v_add_u32 v96, v118, v114
    v_xor_b32 v114, 1, v113
    v_lshlrev_b32 v114, 5, v114
    v_add_u32 v97, v118, v114
    v_xor_b32 v114, 2, v113
    v_lshlrev_b32 v114, 5, v114
    v_add_u32 v98, v118, v114
    v_xor_b32 v114, 3, v113
    v_lshlrev_b32 v114, 5, v114
    v_add_u32 v99, v118, v114
    s_and_b32 s40, s38, 1
    s_lshl_b32 s40, s40, 13
    s_add_u32 s40, s40, 65536
    v_add_u32 v104, s40, v107
    s_waitcnt vmcnt(0)
    s_barrier
    s_cmp_ge_u32 s4, 30
    s_cbranch_scc1 L_fin
    s_mul_i32 s40, s60, 327680
    s_mul_i32 s41, s5, 1280
    s_add_u32 s40, s40, s41
    s_lshl_b32 s41, s61, 8
    s_add_u32 s40, s40, s41
    s_add_u32 s80, s92, s40
    s_addc_u32 s81, s93, 0
    s_sub_u32 s82, 1966080, s40
    s_mov_b32 s83, 0x00020000
    s_mul_i32 s63, s5, 30
    s_add_u32 s63, s63, s4
    s_lshl_b32 s40, s63, 18
    s_add_u32 s40, s40, 16777216
    s_add_u32 s72, s36, s40
    s_addc_u32 s73, s37, 0
    s_mov_b32 s74, 262144
    s_mov_b32 s75, 0x00020000
    s_barrier
    s_barrier
    s_barrier
    ds_read_b128 a[32:35], v104 offset:0
    ds_read_b128 a[36:39], v104 offset:2048
    ds_read_b128 a[40:43], v104 offset:4096
    ds_read_b128 a[44:47], v104 offset:6144
    ds_read_b64_tr_b16 a[0:1], v96 offset:0
    ds_read_b64_tr_b16 a[2:3], v96 offset:4096
    ds_read_b64_tr_b16 a[4:5], v97 offset:0
    ds_read_b64_tr_b16 a[6:7], v97 offset:4096
    ds_read_b64_tr_b16 a[8:9], v98 offset:0
    ds_read_b64_tr_b16 a[10:11], v98 offset:4096
    ds_read_b64_tr_b16 a[12:13], v99 offset:0
    ds_read_b64_tr_b16 a[14:15], v99 offset:4096
    s_waitcnt lgkmcnt(0)
    v_mfma_f32_16x16x32_bf16 v[0:3], a[0:3], a[32:35], 0
    ds_read_b128 a[48:51], v104 offset:1024
    v_mfma_f32_16x16x32_bf16 v[4:7], a[0:3], a[36:39], 0
    ds_read_b128 a[52:55], v104 offset:3072
    v_mfma_f32_16x16x32_bf16 v[8:11], a[0:3], a[40:43], 0
    ds_read_b128 a[56:59], v104 offset:5120
    v_mfma_f32_16x16x32_bf16 v[12:15], a[0:3], a[44:47], 0
    ds_read_b128 a[60:63], v104 offset:7168
    v_mfma_f32_16x16x32_bf16 v[16:19], a[4:7], a[32:35], 0
    ds_read_b64_tr_b16 a[16:17], v96 offset:8192
    v_mfma_f32_16x16x32_bf16 v[20:23], a[4:7], a[36:39], 0
    ds_read_b64_tr_b16 a[18:19], v96 offset:12288
    v_mfma_f32_16x16x32_bf16 v[24:27], a[4:7], a[40:43], 0
    ds_read_b64_tr_b16 a[20:21], v97 offset:8192
    v_mfma_f32_16x16x32_bf16 v[28:31], a[4:7], a[44:47], 0
    ds_read_b64_tr_b16 a[22:23], v97 offset:12288
    v_mfma_f32_16x16x32_bf16 v[32:35], a[8:11], a[32:35], 0
    ds_read_b64_tr_b16 a[24:25], v98 offset:8192
    v_mfma_f32_16x16x32_bf16 v[36:39], a[8:11], a[36:39], 0
    ds_read_b64_tr_b16 a[26:27], v98 offset:12288
    v_mfma_f32_16x16x32_bf16 v[40:43], a[8:11], a[40:43], 0
    ds_read_b64_tr_b16 a[28:29], v99 offset:8192
    v_mfma_f32_16x16x32_bf16 v[44:47], a[8:11], a[44:47], 0
    ds_read_b64_tr_b16 a[30:31], v99 offset:12288
    v_mfma_f32_16x16x32_bf16 v[48:51], a[12:15], a[32:35], 0
    v_mfma_f32_16x16x32_bf16 v[52:55], a[12:15], a[36:39], 0
    v_mfma_f32_16x16x32_bf16 v[56:59], a[12:15], a[40:43], 0
    v_mfma_f32_16x16x32_bf16 v[60:63], a[12:15], a[44:47], 0
    s_waitcnt lgkmcnt(0)
    s_barrier
    v_mfma_f32_16x16x32_bf16 v[0:3], a[16:19], a[48:51], v[0:3]
    ds_read_b128 a[32:35], v104 offset:16384
    v_mfma_f32_16x16x32_bf16 v[4:7], a[16:19], a[52:55], v[4:7]
    ds_read_b128 a[36:39], v104 offset:18432
    v_mfma_f32_16x16x32_bf16 v[8:11], a[16:19], a[56:59], v[8:11]
    ds_read_b128 a[40:43], v104 offset:20480
    v_mfma_f32_16x16x32_bf16 v[12:15], a[16:19], a[60:63], v[12:15]
    ds_read_b128 a[44:47], v104 offset:22528
    v_mfma_f32_16x16x32_bf16 v[16:19], a[20:23], a[48:51], v[16:19]
    ds_read_b64_tr_b16 a[0:1], v96 offset:16384
    v_mfma_f32_16x16x32_bf16 v[20:23], a[20:23], a[52:55], v[20:23]
    ds_read_b64_tr_b16 a[2:3], v96 offset:20480
    v_mfma_f32_16x16x32_bf16 v[24:27], a[20:23], a[56:59], v[24:27]
    ds_read_b64_tr_b16 a[4:5], v97 offset:16384
    v_mfma_f32_16x16x32_bf16 v[28:31], a[20:23], a[60:63], v[28:31]
    ds_read_b64_tr_b16 a[6:7], v97 offset:20480
    v_mfma_f32_16x16x32_bf16 v[32:35], a[24:27], a[48:51], v[32:35]
    ds_read_b64_tr_b16 a[8:9], v98 offset:16384
    v_mfma_f32_16x16x32_bf16 v[36:39], a[24:27], a[52:55], v[36:39]
    ds_read_b64_tr_b16 a[10:11], v98 offset:20480
    v_mfma_f32_16x16x32_bf16 v[40:43], a[24:27], a[56:59], v[40:43]
    ds_read_b64_tr_b16 a[12:13], v99 offset:16384
    v_mfma_f32_16x16x32_bf16 v[44:47], a[24:27], a[60:63], v[44:47]
    ds_read_b64_tr_b16 a[14:15], v99 offset:20480
    v_mfma_f32_16x16x32_bf16 v[48:51], a[28:31], a[48:51], v[48:51]
    v_mfma_f32_16x16x32_bf16 v[52:55], a[28:31], a[52:55], v[52:55]
    v_mfma_f32_16x16x32_bf16 v[56:59], a[28:31], a[56:59], v[56:59]
    v_mfma_f32_16x16x32_bf16 v[60:63], a[28:31], a[60:63], v[60:63]
    s_waitcnt lgkmcnt(0)
    v_mfma_f32_16x16x32_bf16 v[0:3], a[0:3], a[32:35], v[0:3]
    ds_read_b128 a[48:51], v104 offset:17408
    v_mfma_f32_16x16x32_bf16 v[4:7], a[0:3], a[36:39], v[4:7]
    ds_read_b128 a[52:55], v104 offset:19456
    v_mfma_f32_16x16x32_bf16 v[8:11], a[0:3], a[40:43], v[8:11]
    ds_read_b128 a[56:59], v104 offset:21504
    v_mfma_f32_16x16x32_bf16 v[12:15], a[0:3], a[44:47], v[12:15]
    ds_read_b128 a[60:63], v104 offset:23552
    v_mfma_f32_16x16x32_bf16 v[16:19], a[4:7], a[32:35], v[16:19]
    ds_read_b64_tr_b16 a[16:17], v96 offset:24576
    v_mfma_f32_16x16x32_bf16 v[20:23], a[4:7], a[36:39], v[20:23]
    ds_read_b64_tr_b16 a[18:19], v96 offset:28672
    v_mfma_f32_16x16x32_bf16 v[24:27], a[4:7], a[40:43], v[24:27]
    ds_read_b64_tr_b16 a[20:21], v97 offset:24576
    v_mfma_f32_16x16x32_bf16 v[28:31], a[4:7], a[44:47], v[28:31]
    ds_read_b64_tr_b16 a[22:23], v97 offset:28672
    v_mfma_f32_16x16x32_bf16 v[32:35], a[8:11], a[32:35], v[32:35]
    ds_read_b64_tr_b16 a[24:25], v98 offset:24576
    v_mfma_f32_16x16x32_bf16 v[36:39], a[8:11], a[36:39], v[36:39]
    ds_read_b64_tr_b16 a[26:27], v98 offset:28672
    v_mfma_f32_16x16x32_bf16 v[40:43], a[8:11], a[40:43], v[40:43]
    ds_read_b64_tr_b16 a[28:29], v99 offset:24576
    v_mfma_f32_16x16x32_bf16 v[44:47], a[8:11], a[44:47], v[44:47]
    ds_read_b64_tr_b16 a[30:31], v99 offset:28672
    v_mfma_f32_16x16x32_bf16 v[48:51], a[12:15], a[32:35], v[48:51]
    v_mfma_f32_16x16x32_bf16 v[52:55], a[12:15], a[36:39], v[52:55]
    v_mfma_f32_16x16x32_bf16 v[56:59], a[12:15], a[40:43], v[56:59]
    v_mfma_f32_16x16x32_bf16 v[60:63], a[12:15], a[44:47], v[60:63]
    s_waitcnt lgkmcnt(0)
    s_barrier
    v_mfma_f32_16x16x32_bf16 v[0:3], a[16:19], a[48:51], v[0:3]
    ds_read_b128 a[32:35], v104 offset:32768
    v_mfma_f32_16x16x32_bf16 v[4:7], a[16:19], a[52:55], v[4:7]
    ds_read_b128 a[36:39], v104 offset:34816
    v_mfma_f32_16x16x32_bf16 v[8:11], a[16:19], a[56:59], v[8:11]
    ds_read_b128 a[40:43], v104 offset:36864
    v_mfma_f32_16x16x32_bf16 v[12:15], a[16:19], a[60:63], v[12:15]
    ds_read_b128 a[44:47], v104 offset:38912
    v_mfma_f32_16x16x32_bf16 v[16:19], a[20:23], a[48:51], v[16:19]
    ds_read_b64_tr_b16 a[0:1], v96 offset:32768
    v_mfma_f32_16x16x32_bf16 v[20:23], a[20:23], a[52:55], v[20:23]
    ds_read_b64_tr_b16 a[2:3], v96 offset:36864
    v_mfma_f32_16x16x32_bf16 v[24:27], a[20:23], a[56:59], v[24:27]
    ds_read_b64_tr_b16 a[4:5], v97 offset:32768
    v_mfma_f32_16x16x32_bf16 v[28:31], a[20:23], a[60:63], v[28:31]
    ds_read_b64_tr_b16 a[6:7], v97 offset:36864
    v_mfma_f32_16x16x32_bf16 v[32:35], a[24:27], a[48:51], v[32:35]
    ds_read_b64_tr_b16 a[8:9], v98 offset:32768
    v_mfma_f32_16x16x32_bf16 v[36:39], a[24:27], a[52:55], v[36:39]
    ds_read_b64_tr_b16 a[10:11], v98 offset:36864
    v_mfma_f32_16x16x32_bf16 v[40:43], a[24:27], a[56:59], v[40:43]
    ds_read_b64_tr_b16 a[12:13], v99 offset:32768
    v_mfma_f32_16x16x32_bf16 v[44:47], a[24:27], a[60:63], v[44:47]
    ds_read_b64_tr_b16 a[14:15], v99 offset:36864
    v_mfma_f32_16x16x32_bf16 v[48:51], a[28:31], a[48:51], v[48:51]
    v_mfma_f32_16x16x32_bf16 v[52:55], a[28:31], a[52:55], v[52:55]
    v_mfma_f32_16x16x32_bf16 v[56:59], a[28:31], a[56:59], v[56:59]
    v_mfma_f32_16x16x32_bf16 v[60:63], a[28:31], a[60:63], v[60:63]
    s_waitcnt lgkmcnt(0)
    v_mfma_f32_16x16x32_bf16 v[0:3], a[0:3], a[32:35], v[0:3]
    ds_read_b128 a[48:51], v104 offset:33792
    v_mfma_f32_16x16x32_bf16 v[4:7], a[0:3], a[36:39], v[4:7]
    ds_read_b128 a[52:55], v104 offset:35840
    v_mfma_f32_16x16x32_bf16 v[8:11], a[0:3], a[40:43], v[8:11]
    ds_read_b128 a[56:59], v104 offset:37888
    v_mfma_f32_16x16x32_bf16 v[12:15], a[0:3], a[44:47], v[12:15]
    ds_read_b128 a[60:63], v104 offset:39936
    v_mfma_f32_16x16x32_bf16 v[16:19], a[4:7], a[32:35], v[16:19]
    ds_read_b64_tr_b16 a[16:17], v96 offset:40960
    v_mfma_f32_16x16x32_bf16 v[20:23], a[4:7], a[36:39], v[20:23]
    ds_read_b64_tr_b16 a[18:19], v96 offset:45056
    v_mfma_f32_16x16x32_bf16 v[24:27], a[4:7], a[40:43], v[24:27]
    ds_read_b64_tr_b16 a[20:21], v97 offset:40960
    v_mfma_f32_16x16x32_bf16 v[28:31], a[4:7], a[44:47], v[28:31]
    ds_read_b64_tr_b16 a[22:23], v97 offset:45056
    v_mfma_f32_16x16x32_bf16 v[32:35], a[8:11], a[32:35], v[32:35]
    ds_read_b64_tr_b16 a[24:25], v98 offset:40960
    v_mfma_f32_16x16x32_bf16 v[36:39], a[8:11], a[36:39], v[36:39]
    ds_read_b64_tr_b16 a[26:27], v98 offset:45056
    v_mfma_f32_16x16x32_bf16 v[40:43], a[8:11], a[40:43], v[40:43]
    ds_read_b64_tr_b16 a[28:29], v99 offset:40960
    v_mfma_f32_16x16x32_bf16 v[44:47], a[8:11], a[44:47], v[44:47]
    ds_read_b64_tr_b16 a[30:31], v99 offset:45056
    v_mfma_f32_16x16x32_bf16 v[48:51], a[12:15], a[32:35], v[48:51]
    v_mfma_f32_16x16x32_bf16 v[52:55], a[12:15], a[36:39], v[52:55]
    v_mfma_f32_16x16x32_bf16 v[56:59], a[12:15], a[40:43], v[56:59]
    v_mfma_f32_16x16x32_bf16 v[60:63], a[12:15], a[44:47], v[60:63]
    s_waitcnt lgkmcnt(0)
    s_barrier
    v_mfma_f32_16x16x32_bf16 v[0:3], a[16:19], a[48:51], v[0:3]
    ds_read_b128 a[32:35], v104 offset:49152
    v_mfma_f32_16x16x32_bf16 v[4:7], a[16:19], a[52:55], v[4:7]
    ds_read_b128 a[36:39], v104 offset:51200
    v_mfma_f32_16x16x32_bf16 v[8:11], a[16:19], a[56:59], v[8:11]
    ds_read_b128 a[40:43], v104 offset:53248
    v_mfma_f32_16x16x32_bf16 v[12:15], a[16:19], a[60:63], v[12:15]
    ds_read_b128 a[44:47], v104 offset:55296
    v_mfma_f32_16x16x32_bf16 v[16:19], a[20:23], a[48:51], v[16:19]
    ds_read_b64_tr_b16 a[0:1], v96 offset:49152
    v_mfma_f32_16x16x32_bf16 v[20:23], a[20:23], a[52:55], v[20:23]
    ds_read_b64_tr_b16 a[2:3], v96 offset:53248
    v_mfma_f32_16x16x32_bf16 v[24:27], a[20:23], a[56:59], v[24:27]
    ds_read_b64_tr_b16 a[4:5], v97 offset:49152
    v_mfma_f32_16x16x32_bf16 v[28:31], a[20:23], a[60:63], v[28:31]
    ds_read_b64_tr_b16 a[6:7], v97 offset:53248
    v_mfma_f32_16x16x32_bf16 v[32:35], a[24:27], a[48:51], v[32:35]
    ds_read_b64_tr_b16 a[8:9], v98 offset:49152
    v_mfma_f32_16x16x32_bf16 v[36:39], a[24:27], a[52:55], v[36:39]
    ds_read_b64_tr_b16 a[10:11], v98 offset:53248
    v_mfma_f32_16x16x32_bf16 v[40:43], a[24:27], a[56:59], v[40:43]
    ds_read_b64_tr_b16 a[12:13], v99 offset:49152
    v_mfma_f32_16x16x32_bf16 v[44:47], a[24:27], a[60:63], v[44:47]
    ds_read_b64_tr_b16 a[14:15], v99 offset:53248
    v_mfma_f32_16x16x32_bf16 v[48:51], a[28:31], a[48:51], v[48:51]
    v_mfma_f32_16x16x32_bf16 v[52:55], a[28:31], a[52:55], v[52:55]
    v_mfma_f32_16x16x32_bf16 v[56:59], a[28:31], a[56:59], v[56:59]
    v_mfma_f32_16x16x32_bf16 v[60:63], a[28:31], a[60:63], v[60:63]
    s_waitcnt lgkmcnt(0)
    v_mfma_f32_16x16x32_bf16 v[0:3], a[0:3], a[32:35], v[0:3]
    ds_read_b128 a[48:51], v104 offset:50176
    v_mfma_f32_16x16x32_bf16 v[4:7], a[0:3], a[36:39], v[4:7]
    ds_read_b128 a[52:55], v104 offset:52224
    v_mfma_f32_16x16x32_bf16 v[8:11], a[0:3], a[40:43], v[8:11]
    ds_read_b128 a[56:59], v104 offset:54272
    v_mfma_f32_16x16x32_bf16 v[12:15], a[0:3], a[44:47], v[12:15]
    ds_read_b128 a[60:63], v104 offset:56320
    v_mfma_f32_16x16x32_bf16 v[16:19], a[4:7], a[32:35], v[16:19]
    ds_read_b64_tr_b16 a[16:17], v96 offset:57344
    v_mfma_f32_16x16x32_bf16 v[20:23], a[4:7], a[36:39], v[20:23]
    ds_read_b64_tr_b16 a[18:19], v96 offset:61440
    v_mfma_f32_16x16x32_bf16 v[24:27], a[4:7], a[40:43], v[24:27]
    ds_read_b64_tr_b16 a[20:21], v97 offset:57344
    v_mfma_f32_16x16x32_bf16 v[28:31], a[4:7], a[44:47], v[28:31]
    ds_read_b64_tr_b16 a[22:23], v97 offset:61440
    v_mfma_f32_16x16x32_bf16 v[32:35], a[8:11], a[32:35], v[32:35]
    ds_read_b64_tr_b16 a[24:25], v98 offset:57344
    v_mfma_f32_16x16x32_bf16 v[36:39], a[8:11], a[36:39], v[36:39]
    ds_read_b64_tr_b16 a[26:27], v98 offset:61440
    v_mfma_f32_16x16x32_bf16 v[40:43], a[8:11], a[40:43], v[40:43]
    ds_read_b64_tr_b16 a[28:29], v99 offset:57344
    v_mfma_f32_16x16x32_bf16 v[44:47], a[8:11], a[44:47], v[44:47]
    ds_read_b64_tr_b16 a[30:31], v99 offset:61440
    v_mfma_f32_16x16x32_bf16 v[48:51], a[12:15], a[32:35], v[48:51]
    v_mfma_f32_16x16x32_bf16 v[52:55], a[12:15], a[36:39], v[52:55]
    v_mfma_f32_16x16x32_bf16 v[56:59], a[12:15], a[40:43], v[56:59]
    v_mfma_f32_16x16x32_bf16 v[60:63], a[12:15], a[44:47], v[60:63]
    s_waitcnt lgkmcnt(0)
    s_barrier
    v_mfma_f32_16x16x32_bf16 v[0:3], a[16:19], a[48:51], v[0:3]
    ds_read_b128 a[32:35], v104 offset:0
    v_mfma_f32_16x16x32_bf16 v[4:7], a[16:19], a[52:55], v[4:7]
    ds_read_b128 a[36:39], v104 offset:2048
    v_mfma_f32_16x16x32_bf16 v[8:11], a[16:19], a[56:59], v[8:11]
    ds_read_b128 a[40:43], v104 offset:4096
    v_mfma_f32_16x16x32_bf16 v[12:15], a[16:19], a[60:63], v[12:15]
    ds_read_b128 a[44:47], v104 offset:6144
    v_mfma_f32_16x16x32_bf16 v[16:19], a[20:23], a[48:51], v[16:19]
    ds_read_b64_tr_b16 a[0:1], v96 offset:0
    v_mfma_f32_16x16x32_bf16 v[20:23], a[20:23], a[52:55], v[20:23]
    ds_read_b64_tr_b16 a[2:3], v96 offset:4096
    v_mfma_f32_16x16x32_bf16 v[24:27], a[20:23], a[56:59], v[24:27]
    ds_read_b64_tr_b16 a[4:5], v97 offset:0
    v_mfma_f32_16x16x32_bf16 v[28:31], a[20:23], a[60:63], v[28:31]
    ds_read_b64_tr_b16 a[6:7], v97 offset:4096
    v_mfma_f32_16x16x32_bf16 v[32:35], a[24:27], a[48:51], v[32:35]
    ds_read_b64_tr_b16 a[8:9], v98 offset:0
    v_mfma_f32_16x16x32_bf16 v[36:39], a[24:27], a[52:55], v[36:39]
    ds_read_b64_tr_b16 a[10:11], v98 offset:4096
    v_mfma_f32_16x16x32_bf16 v[40:43], a[24:27], a[56:59], v[40:43]
    ds_read_b64_tr_b16 a[12:13], v99 offset:0
    v_mfma_f32_16x16x32_bf16 v[44:47], a[24:27], a[60:63], v[44:47]
    ds_read_b64_tr_b16 a[14:15], v99 offset:4096
    v_mfma_f32_16x16x32_bf16 v[48:51], a[28:31], a[48:51], v[48:51]
    v_mfma_f32_16x16x32_bf16 v[52:55], a[28:31], a[52:55], v[52:55]
    v_mfma_f32_16x16x32_bf16 v[56:59], a[28:31], a[56:59], v[56:59]
    v_mfma_f32_16x16x32_bf16 v[60:63], a[28:31], a[60:63], v[60:63]
    s_waitcnt lgkmcnt(0)
    v_mfma_f32_16x16x32_bf16 v[0:3], a[0:3], a[32:35], v[0:3]
    ds_read_b128 a[48:51], v104 offset:1024
    v_mfma_f32_16x16x32_bf16 v[4:7], a[0:3], a[36:39], v[4:7]
    ds_read_b128 a[52:55], v104 offset:3072
    v_mfma_f32_16x16x32_bf16 v[8:11], a[0:3], a[40:43], v[8:11]
    ds_read_b128 a[56:59], v104 offset:5120
    v_mfma_f32_16x16x32_bf16 v[12:15], a[0:3], a[44:47], v[12:15]
    ds_read_b128 a[60:63], v104 offset:7168
    v_mfma_f32_16x16x32_bf16 v[16:19], a[4:7], a[32:35], v[16:19]
    ds_read_b64_tr_b16 a[16:17], v96 offset:8192
    v_mfma_f32_16x16x32_bf16 v[20:23], a[4:7], a[36:39], v[20:23]
    ds_read_b64_tr_b16 a[18:19], v96 offset:12288
    v_mfma_f32_16x16x32_bf16 v[24:27], a[4:7], a[40:43], v[24:27]
    ds_read_b64_tr_b16 a[20:21], v97 offset:8192
    v_mfma_f32_16x16x32_bf16 v[28:31], a[4:7], a[44:47], v[28:31]
    ds_read_b64_tr_b16 a[22:23], v97 offset:12288
    v_mfma_f32_16x16x32_bf16 v[32:35], a[8:11], a[32:35], v[32:35]
    ds_read_b64_tr_b16 a[24:25], v98 offset:8192
    v_mfma_f32_16x16x32_bf16 v[36:39], a[8:11], a[36:39], v[36:39]
    ds_read_b64_tr_b16 a[26:27], v98 offset:12288
    v_mfma_f32_16x16x32_bf16 v[40:43], a[8:11], a[40:43], v[40:43]
    ds_read_b64_tr_b16 a[28:29], v99 offset:8192
    v_mfma_f32_16x16x32_bf16 v[44:47], a[8:11], a[44:47], v[44:47]
    ds_read_b64_tr_b16 a[30:31], v99 offset:12288
    v_mfma_f32_16x16x32_bf16 v[48:51], a[12:15], a[32:35], v[48:51]
    v_mfma_f32_16x16x32_bf16 v[52:55], a[12:15], a[36:39], v[52:55]
    v_mfma_f32_16x16x32_bf16 v[56:59], a[12:15], a[40:43], v[56:59]
    v_mfma_f32_16x16x32_bf16 v[60:63], a[12:15], a[44:47], v[60:63]
    s_waitcnt lgkmcnt(0)
    s_barrier
    v_mfma_f32_16x16x32_bf16 v[0:3], a[16:19], a[48:51], v[0:3]
    ds_read_b128 a[32:35], v104 offset:16384
    v_mfma_f32_16x16x32_bf16 v[4:7], a[16:19], a[52:55], v[4:7]
    ds_read_b128 a[36:39], v104 offset:18432
    v_mfma_f32_16x16x32_bf16 v[8:11], a[16:19], a[56:59], v[8:11]
    ds_read_b128 a[40:43], v104 offset:20480
    v_mfma_f32_16x16x32_bf16 v[12:15], a[16:19], a[60:63], v[12:15]
    ds_read_b128 a[44:47], v104 offset:22528
    v_mfma_f32_16x16x32_bf16 v[16:19], a[20:23], a[48:51], v[16:19]
    ds_read_b64_tr_b16 a[0:1], v96 offset:16384
    v_mfma_f32_16x16x32_bf16 v[20:23], a[20:23], a[52:55], v[20:23]
    ds_read_b64_tr_b16 a[2:3], v96 offset:20480
    v_mfma_f32_16x16x32_bf16 v[24:27], a[20:23], a[56:59], v[24:27]
    ds_read_b64_tr_b16 a[4:5], v97 offset:16384
    v_mfma_f32_16x16x32_bf16 v[28:31], a[20:23], a[60:63], v[28:31]
    ds_read_b64_tr_b16 a[6:7], v97 offset:20480
    v_mfma_f32_16x16x32_bf16 v[32:35], a[24:27], a[48:51], v[32:35]
    ds_read_b64_tr_b16 a[8:9], v98 offset:16384
    v_mfma_f32_16x16x32_bf16 v[36:39], a[24:27], a[52:55], v[36:39]
    ds_read_b64_tr_b16 a[10:11], v98 offset:20480
    v_mfma_f32_16x16x32_bf16 v[40:43], a[24:27], a[56:59], v[40:43]
    ds_read_b64_tr_b16 a[12:13], v99 offset:16384
    v_mfma_f32_16x16x32_bf16 v[44:47], a[24:27], a[60:63], v[44:47]
    ds_read_b64_tr_b16 a[14:15], v99 offset:20480
    v_mfma_f32_16x16x32_bf16 v[48:51], a[28:31], a[48:51], v[48:51]
    v_mfma_f32_16x16x32_bf16 v[52:55], a[28:31], a[52:55], v[52:55]
    v_mfma_f32_16x16x32_bf16 v[56:59], a[28:31], a[56:59], v[56:59]
    v_mfma_f32_16x16x32_bf16 v[60:63], a[28:31], a[60:63], v[60:63]
    s_waitcnt lgkmcnt(0)
    v_mfma_f32_16x16x32_bf16 v[0:3], a[0:3], a[32:35], v[0:3]
    ds_read_b128 a[48:51], v104 offset:17408
    v_mfma_f32_16x16x32_bf16 v[4:7], a[0:3], a[36:39], v[4:7]
    ds_read_b128 a[52:55], v104 offset:19456
    v_mfma_f32_16x16x32_bf16 v[8:11], a[0:3], a[40:43], v[8:11]
    ds_read_b128 a[56:59], v104 offset:21504
    v_mfma_f32_16x16x32_bf16 v[12:15], a[0:3], a[44:47], v[12:15]
    ds_read_b128 a[60:63], v104 offset:23552
    v_mfma_f32_16x16x32_bf16 v[16:19], a[4:7], a[32:35], v[16:19]
    ds_read_b64_tr_b16 a[16:17], v96 offset:24576
    v_mfma_f32_16x16x32_bf16 v[20:23], a[4:7], a[36:39], v[20:23]
    ds_read_b64_tr_b16 a[18:19], v96 offset:28672
    v_mfma_f32_16x16x32_bf16 v[24:27], a[4:7], a[40:43], v[24:27]
    ds_read_b64_tr_b16 a[20:21], v97 offset:24576
    v_mfma_f32_16x16x32_bf16 v[28:31], a[4:7], a[44:47], v[28:31]
    ds_read_b64_tr_b16 a[22:23], v97 offset:28672
    v_mfma_f32_16x16x32_bf16 v[32:35], a[8:11], a[32:35], v[32:35]
    ds_read_b64_tr_b16 a[24:25], v98 offset:24576
    v_mfma_f32_16x16x32_bf16 v[36:39], a[8:11], a[36:39], v[36:39]
    ds_read_b64_tr_b16 a[26:27], v98 offset:28672
    v_mfma_f32_16x16x32_bf16 v[40:43], a[8:11], a[40:43], v[40:43]
    ds_read_b64_tr_b16 a[28:29], v99 offset:24576
    v_mfma_f32_16x16x32_bf16 v[44:47], a[8:11], a[44:47], v[44:47]
    ds_read_b64_tr_b16 a[30:31], v99 offset:28672
    v_mfma_f32_16x16x32_bf16 v[48:51], a[12:15], a[32:35], v[48:51]
    v_mfma_f32_16x16x32_bf16 v[52:55], a[12:15], a[36:39], v[52:55]
    v_mfma_f32_16x16x32_bf16 v[56:59], a[12:15], a[40:43], v[56:59]
    v_mfma_f32_16x16x32_bf16 v[60:63], a[12:15], a[44:47], v[60:63]
    s_waitcnt lgkmcnt(0)
    s_barrier
    v_mfma_f32_16x16x32_bf16 v[0:3], a[16:19], a[48:51], v[0:3]
    ds_read_b128 a[32:35], v104 offset:32768
    v_mfma_f32_16x16x32_bf16 v[4:7], a[16:19], a[52:55], v[4:7]
    ds_read_b128 a[36:39], v104 offset:34816
    v_mfma_f32_16x16x32_bf16 v[8:11], a[16:19], a[56:59], v[8:11]
    ds_read_b128 a[40:43], v104 offset:36864
    v_mfma_f32_16x16x32_bf16 v[12:15], a[16:19], a[60:63], v[12:15]
    ds_read_b128 a[44:47], v104 offset:38912
    v_mfma_f32_16x16x32_bf16 v[16:19], a[20:23], a[48:51], v[16:19]
    ds_read_b64_tr_b16 a[0:1], v96 offset:32768
    v_mfma_f32_16x16x32_bf16 v[20:23], a[20:23], a[52:55], v[20:23]
    ds_read_b64_tr_b16 a[2:3], v96 offset:36864
    v_mfma_f32_16x16x32_bf16 v[24:27], a[20:23], a[56:59], v[24:27]
    ds_read_b64_tr_b16 a[4:5], v97 offset:32768
    v_mfma_f32_16x16x32_bf16 v[28:31], a[20:23], a[60:63], v[28:31]
    ds_read_b64_tr_b16 a[6:7], v97 offset:36864
    v_mfma_f32_16x16x32_bf16 v[32:35], a[24:27], a[48:51], v[32:35]
    ds_read_b64_tr_b16 a[8:9], v98 offset:32768
    v_mfma_f32_16x16x32_bf16 v[36:39], a[24:27], a[52:55], v[36:39]
    ds_read_b64_tr_b16 a[10:11], v98 offset:36864
    v_mfma_f32_16x16x32_bf16 v[40:43], a[24:27], a[56:59], v[40:43]
    ds_read_b64_tr_b16 a[12:13], v99 offset:32768
    v_mfma_f32_16x16x32_bf16 v[44:47], a[24:27], a[60:63], v[44:47]
    ds_read_b64_tr_b16 a[14:15], v99 offset:36864
    v_mfma_f32_16x16x32_bf16 v[48:51], a[28:31], a[48:51], v[48:51]
    v_mfma_f32_16x16x32_bf16 v[52:55], a[28:31], a[52:55], v[52:55]
    v_mfma_f32_16x16x32_bf16 v[56:59], a[28:31], a[56:59], v[56:59]
    v_mfma_f32_16x16x32_bf16 v[60:63], a[28:31], a[60:63], v[60:63]
    s_waitcnt lgkmcnt(0)
    v_mfma_f32_16x16x32_bf16 v[0:3], a[0:3], a[32:35], v[0:3]
    ds_read_b128 a[48:51], v104 offset:33792
    v_mfma_f32_16x16x32_bf16 v[4:7], a[0:3], a[36:39], v[4:7]
    ds_read_b128 a[52:55], v104 offset:35840
    v_mfma_f32_16x16x32_bf16 v[8:11], a[0:3], a[40:43], v[8:11]
    ds_read_b128 a[56:59], v104 offset:37888
    v_mfma_f32_16x16x32_bf16 v[12:15], a[0:3], a[44:47], v[12:15]
    ds_read_b128 a[60:63], v104 offset:39936
    v_mfma_f32_16x16x32_bf16 v[16:19], a[4:7], a[32:35], v[16:19]
    ds_read_b64_tr_b16 a[16:17], v96 offset:40960
    v_mfma_f32_16x16x32_bf16 v[20:23], a[4:7], a[36:39], v[20:23]
    ds_read_b64_tr_b16 a[18:19], v96 offset:45056
    v_mfma_f32_16x16x32_bf16 v[24:27], a[4:7], a[40:43], v[24:27]
    ds_read_b64_tr_b16 a[20:21], v97 offset:40960
    v_mfma_f32_16x16x32_bf16 v[28:31], a[4:7], a[44:47], v[28:31]
    ds_read_b64_tr_b16 a[22:23], v97 offset:45056
    v_mfma_f32_16x16x32_bf16 v[32:35], a[8:11], a[32:35], v[32:35]
    ds_read_b64_tr_b16 a[24:25], v98 offset:40960
    v_mfma_f32_16x16x32_bf16 v[36:39], a[8:11], a[36:39], v[36:39]
    ds_read_b64_tr_b16 a[26:27], v98 offset:45056
    v_mfma_f32_16x16x32_bf16 v[40:43], a[8:11], a[40:43], v[40:43]
    ds_read_b64_tr_b16 a[28:29], v99 offset:40960
    v_mfma_f32_16x16x32_bf16 v[44:47], a[8:11], a[44:47], v[44:47]
    ds_read_b64_tr_b16 a[30:31], v99 offset:45056
    v_mfma_f32_16x16x32_bf16 v[48:51], a[12:15], a[32:35], v[48:51]
    v_mfma_f32_16x16x32_bf16 v[52:55], a[12:15], a[36:39], v[52:55]
    v_mfma_f32_16x16x32_bf16 v[56:59], a[12:15], a[40:43], v[56:59]
    v_mfma_f32_16x16x32_bf16 v[60:63], a[12:15], a[44:47], v[60:63]
    s_waitcnt lgkmcnt(0)
    s_barrier
    v_mfma_f32_16x16x32_bf16 v[0:3], a[16:19], a[48:51], v[0:3]
    ds_read_b128 a[32:35], v104 offset:49152
    v_mfma_f32_16x16x32_bf16 v[4:7], a[16:19], a[52:55], v[4:7]
    ds_read_b128 a[36:39], v104 offset:51200
    v_mfma_f32_16x16x32_bf16 v[8:11], a[16:19], a[56:59], v[8:11]
    ds_read_b128 a[40:43], v104 offset:53248
    v_mfma_f32_16x16x32_bf16 v[12:15], a[16:19], a[60:63], v[12:15]
    ds_read_b128 a[44:47], v104 offset:55296
    v_mfma_f32_16x16x32_bf16 v[16:19], a[20:23], a[48:51], v[16:19]
    ds_read_b64_tr_b16 a[0:1], v96 offset:49152
    v_mfma_f32_16x16x32_bf16 v[20:23], a[20:23], a[52:55], v[20:23]
    ds_read_b64_tr_b16 a[2:3], v96 offset:53248
    v_mfma_f32_16x16x32_bf16 v[24:27], a[20:23], a[56:59], v[24:27]
    ds_read_b64_tr_b16 a[4:5], v97 offset:49152
    v_mfma_f32_16x16x32_bf16 v[28:31], a[20:23], a[60:63], v[28:31]
    ds_read_b64_tr_b16 a[6:7], v97 offset:53248
    v_mfma_f32_16x16x32_bf16 v[32:35], a[24:27], a[48:51], v[32:35]
    ds_read_b64_tr_b16 a[8:9], v98 offset:49152
    v_mfma_f32_16x16x32_bf16 v[36:39], a[24:27], a[52:55], v[36:39]
    ds_read_b64_tr_b16 a[10:11], v98 offset:53248
    v_mfma_f32_16x16x32_bf16 v[40:43], a[24:27], a[56:59], v[40:43]
    ds_read_b64_tr_b16 a[12:13], v99 offset:49152
    v_mfma_f32_16x16x32_bf16 v[44:47], a[24:27], a[60:63], v[44:47]
    ds_read_b64_tr_b16 a[14:15], v99 offset:53248
    v_mfma_f32_16x16x32_bf16 v[48:51], a[28:31], a[48:51], v[48:51]
    v_mfma_f32_16x16x32_bf16 v[52:55], a[28:31], a[52:55], v[52:55]
    v_mfma_f32_16x16x32_bf16 v[56:59], a[28:31], a[56:59], v[56:59]
    v_mfma_f32_16x16x32_bf16 v[60:63], a[28:31], a[60:63], v[60:63]
    s_waitcnt lgkmcnt(0)
    v_mfma_f32_16x16x32_bf16 v[0:3], a[0:3], a[32:35], v[0:3]
    ds_read_b128 a[48:51], v104 offset:50176
    v_mfma_f32_16x16x32_bf16 v[4:7], a[0:3], a[36:39], v[4:7]
    ds_read_b128 a[52:55], v104 offset:52224
    v_mfma_f32_16x16x32_bf16 v[8:11], a[0:3], a[40:43], v[8:11]
    ds_read_b128 a[56:59], v104 offset:54272
    v_mfma_f32_16x16x32_bf16 v[12:15], a[0:3], a[44:47], v[12:15]
    ds_read_b128 a[60:63], v104 offset:56320
    v_mfma_f32_16x16x32_bf16 v[16:19], a[4:7], a[32:35], v[16:19]
    ds_read_b64_tr_b16 a[16:17], v96 offset:57344
    v_mfma_f32_16x16x32_bf16 v[20:23], a[4:7], a[36:39], v[20:23]
    ds_read_b64_tr_b16 a[18:19], v96 offset:61440
    v_mfma_f32_16x16x32_bf16 v[24:27], a[4:7], a[40:43], v[24:27]
    ds_read_b64_tr_b16 a[20:21], v97 offset:57344
    v_mfma_f32_16x16x32_bf16 v[28:31], a[4:7], a[44:47], v[28:31]
    ds_read_b64_tr_b16 a[22:23], v97 offset:61440
    v_mfma_f32_16x16x32_bf16 v[32:35], a[8:11], a[32:35], v[32:35]
    ds_read_b64_tr_b16 a[24:25], v98 offset:57344
    v_mfma_f32_16x16x32_bf16 v[36:39], a[8:11], a[36:39], v[36:39]
    ds_read_b64_tr_b16 a[26:27], v98 offset:61440
    v_mfma_f32_16x16x32_bf16 v[40:43], a[8:11], a[40:43], v[40:43]
    ds_read_b64_tr_b16 a[28:29], v99 offset:57344
    v_mfma_f32_16x16x32_bf16 v[44:47], a[8:11], a[44:47], v[44:47]
    ds_read_b64_tr_b16 a[30:31], v99 offset:61440
    v_mfma_f32_16x16x32_bf16 v[48:51], a[12:15], a[32:35], v[48:51]
    v_mfma_f32_16x16x32_bf16 v[52:55], a[12:15], a[36:39], v[52:55]
    v_mfma_f32_16x16x32_bf16 v[56:59], a[12:15], a[40:43], v[56:59]
    v_mfma_f32_16x16x32_bf16 v[60:63], a[12:15], a[44:47], v[60:63]
    s_waitcnt lgkmcnt(0)
    s_barrier
    v_mov_b32 v112, 0
    buffer_load_dwordx2 v[116:117], v112, s[84:87], 0 offen sc0 sc1
    v_mfma_f32_16x16x32_bf16 v[0:3], a[16:19], a[48:51], v[0:3]
    ds_read_b128 a[32:35], v104 offset:0
    v_mfma_f32_16x16x32_bf16 v[4:7], a[16:19], a[52:55], v[4:7]
    ds_read_b128 a[36:39], v104 offset:2048
    v_mfma_f32_16x16x32_bf16 v[8:11], a[16:19], a[56:59], v[8:11]
    ds_read_b128 a[40:43], v104 offset:4096
    v_mfma_f32_16x16x32_bf16 v[12:15], a[16:19], a[60:63], v[12:15]
    ds_read_b128 a[44:47], v104 offset:6144
    v_mfma_f32_16x16x32_bf16 v[16:19], a[20:23], a[48:51], v[16:19]
    ds_read_b64_tr_b16 a[0:1], v96 offset:0
    v_mfma_f32_16x16x32_bf16 v[20:23], a[20:23], a[52:55], v[20:23]
    ds_read_b64_tr_b16 a[2:3], v96 offset:4096
    v_mfma_f32_16x16x32_bf16 v[24:27], a[20:23], a[56:59], v[24:27]
    ds_read_b64_tr_b16 a[4:5], v97 offset:0
    v_mfma_f32_16x16x32_bf16 v[28:31], a[20:23], a[60:63], v[28:31]
    ds_read_b64_tr_b16 a[6:7], v97 offset:4096
    v_mfma_f32_16x16x32_bf16 v[32:35], a[24:27], a[48:51], v[32:35]
    ds_read_b64_tr_b16 a[8:9], v98 offset:0
    v_mfma_f32_16x16x32_bf16 v[36:39], a[24:27], a[52:55], v[36:39]
    ds_read_b64_tr_b16 a[10:11], v98 offset:4096
    v_mfma_f32_16x16x32_bf16 v[40:43], a[24:27], a[56:59], v[40:43]
    ds_read_b64_tr_b16 a[12:13], v99 offset:0
    v_mfma_f32_16x16x32_bf16 v[44:47], a[24:27], a[60:63], v[44:47]
    ds_read_b64_tr_b16 a[14:15], v99 offset:4096
    v_mfma_f32_16x16x32_bf16 v[48:51], a[28:31], a[48:51], v[48:51]
    v_mfma_f32_16x16x32_bf16 v[52:55], a[28:31], a[52:55], v[52:55]
    v_mfma_f32_16x16x32_bf16 v[56:59], a[28:31], a[56:59], v[56:59]
    v_mfma_f32_16x16x32_bf16 v[60:63], a[28:31], a[60:63], v[60:63]
    s_waitcnt lgkmcnt(0)
    v_mfma_f32_16x16x32_bf16 v[0:3], a[0:3], a[32:35], v[0:3]
    ds_read_b128 a[48:51], v104 offset:1024
    v_mfma_f32_16x16x32_bf16 v[4:7], a[0:3], a[36:39], v[4:7]
    ds_read_b128 a[52:55], v104 offset:3072
    v_mfma_f32_16x16x32_bf16 v[8:11], a[0:3], a[40:43], v[8:11]
    ds_read_b128 a[56:59], v104 offset:5120
    v_mfma_f32_16x16x32_bf16 v[12:15], a[0:3], a[44:47], v[12:15]
    ds_read_b128 a[60:63], v104 offset:7168
    v_mfma_f32_16x16x32_bf16 v[16:19], a[4:7], a[32:35], v[16:19]
    ds_read_b64_tr_b16 a[16:17], v96 offset:8192
    v_mfma_f32_16x16x32_bf16 v[20:23], a[4:7], a[36:39], v[20:23]
    ds_read_b64_tr_b16 a[18:19], v96 offset:12288
    v_mfma_f32_16x16x32_bf16 v[24:27], a[4:7], a[40:43], v[24:27]
    ds_read_b64_tr_b16 a[20:21], v97 offset:8192
    v_mfma_f32_16x16x32_bf16 v[28:31], a[4:7], a[44:47], v[28:31]
    ds_read_b64_tr_b16 a[22:23], v97 offset:12288
    v_mfma_f32_16x16x32_bf16 v[32:35], a[8:11], a[32:35], v[32:35]
    ds_read_b64_tr_b16 a[24:25], v98 offset:8192
    v_mfma_f32_16x16x32_bf16 v[36:39], a[8:11], a[36:39], v[36:39]
    ds_read_b64_tr_b16 a[26:27], v98 offset:12288
    v_mfma_f32_16x16x32_bf16 v[40:43], a[8:11], a[40:43], v[40:43]
    ds_read_b64_tr_b16 a[28:29], v99 offset:8192
    v_mfma_f32_16x16x32_bf16 v[44:47], a[8:11], a[44:47], v[44:47]
    ds_read_b64_tr_b16 a[30:31], v99 offset:12288
    v_mfma_f32_16x16x32_bf16 v[48:51], a[12:15], a[32:35], v[48:51]
    v_mfma_f32_16x16x32_bf16 v[52:55], a[12:15], a[36:39], v[52:55]
    v_mfma_f32_16x16x32_bf16 v[56:59], a[12:15], a[40:43], v[56:59]
    v_mfma_f32_16x16x32_bf16 v[60:63], a[12:15], a[44:47], v[60:63]
    s_waitcnt lgkmcnt(0)
    s_barrier
    v_mfma_f32_16x16x32_bf16 v[0:3], a[16:19], a[48:51], v[0:3]
    ds_read_b128 a[32:35], v104 offset:16384
    v_mfma_f32_16x16x32_bf16 v[4:7], a[16:19], a[52:55], v[4:7]
    ds_read_b128 a[36:39], v104 offset:18432
    v_mfma_f32_16x16x32_bf16 v[8:11], a[16:19], a[56:59], v[8:11]
    ds_read_b128 a[40:43], v104 offset:20480
    v_mfma_f32_16x16x32_bf16 v[12:15], a[16:19], a[60:63], v[12:15]
    ds_read_b128 a[44:47], v104 offset:22528
    v_mfma_f32_16x16x32_bf16 v[16:19], a[20:23], a[48:51], v[16:19]
    ds_read_b64_tr_b16 a[0:1], v96 offset:16384
    v_mfma_f32_16x16x32_bf16 v[20:23], a[20:23], a[52:55], v[20:23]
    ds_read_b64_tr_b16 a[2:3], v96 offset:20480
    v_mfma_f32_16x16x32_bf16 v[24:27], a[20:23], a[56:59], v[24:27]
    ds_read_b64_tr_b16 a[4:5], v97 offset:16384
    v_mfma_f32_16x16x32_bf16 v[28:31], a[20:23], a[60:63], v[28:31]
    ds_read_b64_tr_b16 a[6:7], v97 offset:20480
    v_mfma_f32_16x16x32_bf16 v[32:35], a[24:27], a[48:51], v[32:35]
    ds_read_b64_tr_b16 a[8:9], v98 offset:16384
    v_mfma_f32_16x16x32_bf16 v[36:39], a[24:27], a[52:55], v[36:39]
    ds_read_b64_tr_b16 a[10:11], v98 offset:20480
    v_mfma_f32_16x16x32_bf16 v[40:43], a[24:27], a[56:59], v[40:43]
    ds_read_b64_tr_b16 a[12:13], v99 offset:16384
    v_mfma_f32_16x16x32_bf16 v[44:47], a[24:27], a[60:63], v[44:47]
    ds_read_b64_tr_b16 a[14:15], v99 offset:20480
    v_mfma_f32_16x16x32_bf16 v[48:51], a[28:31], a[48:51], v[48:51]
    v_mfma_f32_16x16x32_bf16 v[52:55], a[28:31], a[52:55], v[52:55]
    v_mfma_f32_16x16x32_bf16 v[56:59], a[28:31], a[56:59], v[56:59]
    v_mfma_f32_16x16x32_bf16 v[60:63], a[28:31], a[60:63], v[60:63]
    s_waitcnt lgkmcnt(0)
    v_mfma_f32_16x16x32_bf16 v[0:3], a[0:3], a[32:35], v[0:3]
    ds_read_b128 a[48:51], v104 offset:17408
    v_mfma_f32_16x16x32_bf16 v[4:7], a[0:3], a[36:39], v[4:7]
    ds_read_b128 a[52:55], v104 offset:19456
    v_mfma_f32_16x16x32_bf16 v[8:11], a[0:3], a[40:43], v[8:11]
    ds_read_b128 a[56:59], v104 offset:21504
    v_mfma_f32_16x16x32_bf16 v[12:15], a[0:3], a[44:47], v[12:15]
    ds_read_b128 a[60:63], v104 offset:23552
    v_mfma_f32_16x16x32_bf16 v[16:19], a[4:7], a[32:35], v[16:19]
    ds_read_b64_tr_b16 a[16:17], v96 offset:24576
    v_mfma_f32_16x16x32_bf16 v[20:23], a[4:7], a[36:39], v[20:23]
    ds_read_b64_tr_b16 a[18:19], v96 offset:28672
    v_mfma_f32_16x16x32_bf16 v[24:27], a[4:7], a[40:43], v[24:27]
    ds_read_b64_tr_b16 a[20:21], v97 offset:24576
    v_mfma_f32_16x16x32_bf16 v[28:31], a[4:7], a[44:47], v[28:31]
    ds_read_b64_tr_b16 a[22:23], v97 offset:28672
    v_mfma_f32_16x16x32_bf16 v[32:35], a[8:11], a[32:35], v[32:35]
    ds_read_b64_tr_b16 a[24:25], v98 offset:24576
    v_mfma_f32_16x16x32_bf16 v[36:39], a[8:11], a[36:39], v[36:39]
    ds_read_b64_tr_b16 a[26:27], v98 offset:28672
    v_mfma_f32_16x16x32_bf16 v[40:43], a[8:11], a[40:43], v[40:43]
    ds_read_b64_tr_b16 a[28:29], v99 offset:24576
    v_mfma_f32_16x16x32_bf16 v[44:47], a[8:11], a[44:47], v[44:47]
    ds_read_b64_tr_b16 a[30:31], v99 offset:28672
    v_mfma_f32_16x16x32_bf16 v[48:51], a[12:15], a[32:35], v[48:51]
    v_mfma_f32_16x16x32_bf16 v[52:55], a[12:15], a[36:39], v[52:55]
    v_mfma_f32_16x16x32_bf16 v[56:59], a[12:15], a[40:43], v[56:59]
    v_mfma_f32_16x16x32_bf16 v[60:63], a[12:15], a[44:47], v[60:63]
    s_waitcnt lgkmcnt(0)
    s_barrier
    v_mfma_f32_16x16x32_bf16 v[0:3], a[16:19], a[48:51], v[0:3]
    ds_read_b128 a[32:35], v104 offset:32768
    v_mfma_f32_16x16x32_bf16 v[4:7], a[16:19], a[52:55], v[4:7]
    ds_read_b128 a[36:39], v104 offset:34816
    v_mfma_f32_16x16x32_bf16 v[8:11], a[16:19], a[56:59], v[8:11]
    ds_read_b128 a[40:43], v104 offset:36864
    v_mfma_f32_16x16x32_bf16 v[12:15], a[16:19], a[60:63], v[12:15]
    ds_read_b128 a[44:47], v104 offset:38912
    v_mfma_f32_16x16x32_bf16 v[16:19], a[20:23], a[48:51], v[16:19]
    ds_read_b64_tr_b16 a[0:1], v96 offset:32768
    v_mfma_f32_16x16x32_bf16 v[20:23], a[20:23], a[52:55], v[20:23]
    ds_read_b64_tr_b16 a[2:3], v96 offset:36864
    v_mfma_f32_16x16x32_bf16 v[24:27], a[20:23], a[56:59], v[24:27]
    ds_read_b64_tr_b16 a[4:5], v97 offset:32768
    v_mfma_f32_16x16x32_bf16 v[28:31], a[20:23], a[60:63], v[28:31]
    ds_read_b64_tr_b16 a[6:7], v97 offset:36864
    v_mfma_f32_16x16x32_bf16 v[32:35], a[24:27], a[48:51], v[32:35]
    ds_read_b64_tr_b16 a[8:9], v98 offset:32768
    v_mfma_f32_16x16x32_bf16 v[36:39], a[24:27], a[52:55], v[36:39]
    ds_read_b64_tr_b16 a[10:11], v98 offset:36864
    v_mfma_f32_16x16x32_bf16 v[40:43], a[24:27], a[56:59], v[40:43]
    ds_read_b64_tr_b16 a[12:13], v99 offset:32768
    v_mfma_f32_16x16x32_bf16 v[44:47], a[24:27], a[60:63], v[44:47]
    ds_read_b64_tr_b16 a[14:15], v99 offset:36864
    v_mfma_f32_16x16x32_bf16 v[48:51], a[28:31], a[48:51], v[48:51]
    v_mfma_f32_16x16x32_bf16 v[52:55], a[28:31], a[52:55], v[52:55]
    v_mfma_f32_16x16x32_bf16 v[56:59], a[28:31], a[56:59], v[56:59]
    v_mfma_f32_16x16x32_bf16 v[60:63], a[28:31], a[60:63], v[60:63]
    s_waitcnt lgkmcnt(0)
    v_mfma_f32_16x16x32_bf16 v[0:3], a[0:3], a[32:35], v[0:3]
    ds_read_b128 a[48:51], v104 offset:33792
    v_mfma_f32_16x16x32_bf16 v[4:7], a[0:3], a[36:39], v[4:7]
    ds_read_b128 a[52:55], v104 offset:35840
    v_mfma_f32_16x16x32_bf16 v[8:11], a[0:3], a[40:43], v[8:11]
    ds_read_b128 a[56:59], v104 offset:37888
    v_mfma_f32_16x16x32_bf16 v[12:15], a[0:3], a[44:47], v[12:15]
    ds_read_b128 a[60:63], v104 offset:39936
    v_mfma_f32_16x16x32_bf16 v[16:19], a[4:7], a[32:35], v[16:19]
    ds_read_b64_tr_b16 a[16:17], v96 offset:40960
    v_mfma_f32_16x16x32_bf16 v[20:23], a[4:7], a[36:39], v[20:23]
    ds_read_b64_tr_b16 a[18:19], v96 offset:45056
    v_mfma_f32_16x16x32_bf16 v[24:27], a[4:7], a[40:43], v[24:27]
    ds_read_b64_tr_b16 a[20:21], v97 offset:40960
    v_mfma_f32_16x16x32_bf16 v[28:31], a[4:7], a[44:47], v[28:31]
    ds_read_b64_tr_b16 a[22:23], v97 offset:45056
    v_mfma_f32_16x16x32_bf16 v[32:35], a[8:11], a[32:35], v[32:35]
    ds_read_b64_tr_b16 a[24:25], v98 offset:40960
    v_mfma_f32_16x16x32_bf16 v[36:39], a[8:11], a[36:39], v[36:39]
    ds_read_b64_tr_b16 a[26:27], v98 offset:45056
    v_mfma_f32_16x16x32_bf16 v[40:43], a[8:11], a[40:43], v[40:43]
    ds_read_b64_tr_b16 a[28:29], v99 offset:40960
    v_mfma_f32_16x16x32_bf16 v[44:47], a[8:11], a[44:47], v[44:47]
    ds_read_b64_tr_b16 a[30:31], v99 offset:45056
    v_mfma_f32_16x16x32_bf16 v[48:51], a[12:15], a[32:35], v[48:51]
    v_mfma_f32_16x16x32_bf16 v[52:55], a[12:15], a[36:39], v[52:55]
    v_mfma_f32_16x16x32_bf16 v[56:59], a[12:15], a[40:43], v[56:59]
    v_mfma_f32_16x16x32_bf16 v[60:63], a[12:15], a[44:47], v[60:63]
    s_waitcnt lgkmcnt(0)
    s_barrier
    v_mfma_f32_16x16x32_bf16 v[0:3], a[16:19], a[48:51], v[0:3]
    ds_read_b128 a[32:35], v104 offset:49152
    v_mfma_f32_16x16x32_bf16 v[4:7], a[16:19], a[52:55], v[4:7]
    ds_read_b128 a[36:39], v104 offset:51200
    v_mfma_f32_16x16x32_bf16 v[8:11], a[16:19], a[56:59], v[8:11]
    ds_read_b128 a[40:43], v104 offset:53248
    v_mfma_f32_16x16x32_bf16 v[12:15], a[16:19], a[60:63], v[12:15]
    ds_read_b128 a[44:47], v104 offset:55296
    v_mfma_f32_16x16x32_bf16 v[16:19], a[20:23], a[48:51], v[16:19]
    ds_read_b64_tr_b16 a[0:1], v96 offset:49152
    v_mfma_f32_16x16x32_bf16 v[20:23], a[20:23], a[52:55], v[20:23]
    ds_read_b64_tr_b16 a[2:3], v96 offset:53248
    v_mfma_f32_16x16x32_bf16 v[24:27], a[20:23], a[56:59], v[24:27]
    ds_read_b64_tr_b16 a[4:5], v97 offset:49152
    v_mfma_f32_16x16x32_bf16 v[28:31], a[20:23], a[60:63], v[28:31]
    ds_read_b64_tr_b16 a[6:7], v97 offset:53248
    v_mfma_f32_16x16x32_bf16 v[32:35], a[24:27], a[48:51], v[32:35]
    ds_read_b64_tr_b16 a[8:9], v98 offset:49152
    v_mfma_f32_16x16x32_bf16 v[36:39], a[24:27], a[52:55], v[36:39]
    ds_read_b64_tr_b16 a[10:11], v98 offset:53248
    v_mfma_f32_16x16x32_bf16 v[40:43], a[24:27], a[56:59], v[40:43]
    ds_read_b64_tr_b16 a[12:13], v99 offset:49152
    v_mfma_f32_16x16x32_bf16 v[44:47], a[24:27], a[60:63], v[44:47]
    ds_read_b64_tr_b16 a[14:15], v99 offset:53248
    v_mfma_f32_16x16x32_bf16 v[48:51], a[28:31], a[48:51], v[48:51]
    v_mfma_f32_16x16x32_bf16 v[52:55], a[28:31], a[52:55], v[52:55]
    v_mfma_f32_16x16x32_bf16 v[56:59], a[28:31], a[56:59], v[56:59]
    v_mfma_f32_16x16x32_bf16 v[60:63], a[28:31], a[60:63], v[60:63]
    s_waitcnt lgkmcnt(0)
    v_mfma_f32_16x16x32_bf16 v[0:3], a[0:3], a[32:35], v[0:3]
    ds_read_b128 a[48:51], v104 offset:50176
    v_mfma_f32_16x16x32_bf16 v[4:7], a[0:3], a[36:39], v[4:7]
    ds_read_b128 a[52:55], v104 offset:52224
    v_mfma_f32_16x16x32_bf16 v[8:11], a[0:3], a[40:43], v[8:11]
    ds_read_b128 a[56:59], v104 offset:54272
    v_mfma_f32_16x16x32_bf16 v[12:15], a[0:3], a[44:47], v[12:15]
    ds_read_b128 a[60:63], v104 offset:56320
    v_mfma_f32_16x16x32_bf16 v[16:19], a[4:7], a[32:35], v[16:19]
    ds_read_b64_tr_b16 a[16:17], v96 offset:57344
    v_mfma_f32_16x16x32_bf16 v[20:23], a[4:7], a[36:39], v[20:23]
    ds_read_b64_tr_b16 a[18:19], v96 offset:61440
    v_mfma_f32_16x16x32_bf16 v[24:27], a[4:7], a[40:43], v[24:27]
    ds_read_b64_tr_b16 a[20:21], v97 offset:57344
    v_mfma_f32_16x16x32_bf16 v[28:31], a[4:7], a[44:47], v[28:31]
    ds_read_b64_tr_b16 a[22:23], v97 offset:61440
    v_mfma_f32_16x16x32_bf16 v[32:35], a[8:11], a[32:35], v[32:35]
    ds_read_b64_tr_b16 a[24:25], v98 offset:57344
    v_mfma_f32_16x16x32_bf16 v[36:39], a[8:11], a[36:39], v[36:39]
    ds_read_b64_tr_b16 a[26:27], v98 offset:61440
    v_mfma_f32_16x16x32_bf16 v[40:43], a[8:11], a[40:43], v[40:43]
    ds_read_b64_tr_b16 a[28:29], v99 offset:57344
    v_mfma_f32_16x16x32_bf16 v[44:47], a[8:11], a[44:47], v[44:47]
    ds_read_b64_tr_b16 a[30:31], v99 offset:61440
    v_mfma_f32_16x16x32_bf16 v[48:51], a[12:15], a[32:35], v[48:51]
    v_mfma_f32_16x16x32_bf16 v[52:55], a[12:15], a[36:39], v[52:55]
    v_mfma_f32_16x16x32_bf16 v[56:59], a[12:15], a[40:43], v[56:59]
    v_mfma_f32_16x16x32_bf16 v[60:63], a[12:15], a[44:47], v[60:63]
    s_waitcnt lgkmcnt(0)
    s_barrier
    v_mfma_f32_16x16x32_bf16 v[0:3], a[16:19], a[48:51], v[0:3]
    ds_read_b128 a[32:35], v104 offset:0
    v_mfma_f32_16x16x32_bf16 v[4:7], a[16:19], a[52:55], v[4:7]
    ds_read_b128 a[36:39], v104 offset:2048
    v_mfma_f32_16x16x32_bf16 v[8:11], a[16:19], a[56:59], v[8:11]
    ds_read_b128 a[40:43], v104 offset:4096
    v_mfma_f32_16x16x32_bf16 v[12:15], a[16:19], a[60:63], v[12:15]
    ds_read_b128 a[44:47], v104 offset:6144
    v_mfma_f32_16x16x32_bf16 v[16:19], a[20:23], a[48:51], v[16:19]
    ds_read_b64_tr_b16 a[0:1], v96 offset:0
    v_mfma_f32_16x16x32_bf16 v[20:23], a[20:23], a[52:55], v[20:23]
    ds_read_b64_tr_b16 a[2:3], v96 offset:4096
    v_mfma_f32_16x16x32_bf16 v[24:27], a[20:23], a[56:59], v[24:27]
    ds_read_b64_tr_b16 a[4:5], v97 offset:0
    v_mfma_f32_16x16x32_bf16 v[28:31], a[20:23], a[60:63], v[28:31]
    ds_read_b64_tr_b16 a[6:7], v97 offset:4096
    v_mfma_f32_16x16x32_bf16 v[32:35], a[24:27], a[48:51], v[32:35]
    ds_read_b64_tr_b16 a[8:9], v98 offset:0
    v_mfma_f32_16x16x32_bf16 v[36:39], a[24:27], a[52:55], v[36:39]
    ds_read_b64_tr_b16 a[10:11], v98 offset:4096
    v_mfma_f32_16x16x32_bf16 v[40:43], a[24:27], a[56:59], v[40:43]
    ds_read_b64_tr_b16 a[12:13], v99 offset:0
    v_mfma_f32_16x16x32_bf16 v[44:47], a[24:27], a[60:63], v[44:47]
    ds_read_b64_tr_b16 a[14:15], v99 offset:4096
    v_mfma_f32_16x16x32_bf16 v[48:51], a[28:31], a[48:51], v[48:51]
    v_mfma_f32_16x16x32_bf16 v[52:55], a[28:31], a[52:55], v[52:55]
    v_mfma_f32_16x16x32_bf16 v[56:59], a[28:31], a[56:59], v[56:59]
    v_mfma_f32_16x16x32_bf16 v[60:63], a[28:31], a[60:63], v[60:63]
    s_waitcnt lgkmcnt(0)
    v_mfma_f32_16x16x32_bf16 v[0:3], a[0:3], a[32:35], v[0:3]
    ds_read_b128 a[48:51], v104 offset:1024
    v_mfma_f32_16x16x32_bf16 v[4:7], a[0:3], a[36:39], v[4:7]
    ds_read_b128 a[52:55], v104 offset:3072
    v_mfma_f32_16x16x32_bf16 v[8:11], a[0:3], a[40:43], v[8:11]
    ds_read_b128 a[56:59], v104 offset:5120
    v_mfma_f32_16x16x32_bf16 v[12:15], a[0:3], a[44:47], v[12:15]
    ds_read_b128 a[60:63], v104 offset:7168
    v_mfma_f32_16x16x32_bf16 v[16:19], a[4:7], a[32:35], v[16:19]
    ds_read_b64_tr_b16 a[16:17], v96 offset:8192
    v_mfma_f32_16x16x32_bf16 v[20:23], a[4:7], a[36:39], v[20:23]
    ds_read_b64_tr_b16 a[18:19], v96 offset:12288
    v_mfma_f32_16x16x32_bf16 v[24:27], a[4:7], a[40:43], v[24:27]
    ds_read_b64_tr_b16 a[20:21], v97 offset:8192
    v_mfma_f32_16x16x32_bf16 v[28:31], a[4:7], a[44:47], v[28:31]
    ds_read_b64_tr_b16 a[22:23], v97 offset:12288
    v_mfma_f32_16x16x32_bf16 v[32:35], a[8:11], a[32:35], v[32:35]
    ds_read_b64_tr_b16 a[24:25], v98 offset:8192
    v_mfma_f32_16x16x32_bf16 v[36:39], a[8:11], a[36:39], v[36:39]
    ds_read_b64_tr_b16 a[26:27], v98 offset:12288
    v_mfma_f32_16x16x32_bf16 v[40:43], a[8:11], a[40:43], v[40:43]
    ds_read_b64_tr_b16 a[28:29], v99 offset:8192
    v_mfma_f32_16x16x32_bf16 v[44:47], a[8:11], a[44:47], v[44:47]
    ds_read_b64_tr_b16 a[30:31], v99 offset:12288
    v_mfma_f32_16x16x32_bf16 v[48:51], a[12:15], a[32:35], v[48:51]
    v_mfma_f32_16x16x32_bf16 v[52:55], a[12:15], a[36:39], v[52:55]
    v_mfma_f32_16x16x32_bf16 v[56:59], a[12:15], a[40:43], v[56:59]
    v_mfma_f32_16x16x32_bf16 v[60:63], a[12:15], a[44:47], v[60:63]
    s_waitcnt lgkmcnt(0)
    s_barrier
    v_mfma_f32_16x16x32_bf16 v[0:3], a[16:19], a[48:51], v[0:3]
    ds_read_b128 a[32:35], v104 offset:16384
    v_mfma_f32_16x16x32_bf16 v[4:7], a[16:19], a[52:55], v[4:7]
    ds_read_b128 a[36:39], v104 offset:18432
    v_mfma_f32_16x16x32_bf16 v[8:11], a[16:19], a[56:59], v[8:11]
    ds_read_b128 a[40:43], v104 offset:20480
    v_mfma_f32_16x16x32_bf16 v[12:15], a[16:19], a[60:63], v[12:15]
    ds_read_b128 a[44:47], v104 offset:22528
    v_mfma_f32_16x16x32_bf16 v[16:19], a[20:23], a[48:51], v[16:19]
    ds_read_b64_tr_b16 a[0:1], v96 offset:16384
    v_mfma_f32_16x16x32_bf16 v[20:23], a[20:23], a[52:55], v[20:23]
    ds_read_b64_tr_b16 a[2:3], v96 offset:20480
    v_mfma_f32_16x16x32_bf16 v[24:27], a[20:23], a[56:59], v[24:27]
    ds_read_b64_tr_b16 a[4:5], v97 offset:16384
    v_mfma_f32_16x16x32_bf16 v[28:31], a[20:23], a[60:63], v[28:31]
    ds_read_b64_tr_b16 a[6:7], v97 offset:20480
    v_mfma_f32_16x16x32_bf16 v[32:35], a[24:27], a[48:51], v[32:35]
    ds_read_b64_tr_b16 a[8:9], v98 offset:16384
    v_mfma_f32_16x16x32_bf16 v[36:39], a[24:27], a[52:55], v[36:39]
    ds_read_b64_tr_b16 a[10:11], v98 offset:20480
    v_mfma_f32_16x16x32_bf16 v[40:43], a[24:27], a[56:59], v[40:43]
    ds_read_b64_tr_b16 a[12:13], v99 offset:16384
    v_mfma_f32_16x16x32_bf16 v[44:47], a[24:27], a[60:63], v[44:47]
    ds_read_b64_tr_b16 a[14:15], v99 offset:20480
    v_mfma_f32_16x16x32_bf16 v[48:51], a[28:31], a[48:51], v[48:51]
    v_mfma_f32_16x16x32_bf16 v[52:55], a[28:31], a[52:55], v[52:55]
    v_mfma_f32_16x16x32_bf16 v[56:59], a[28:31], a[56:59], v[56:59]
    v_mfma_f32_16x16x32_bf16 v[60:63], a[28:31], a[60:63], v[60:63]
    s_waitcnt lgkmcnt(0)
    v_mfma_f32_16x16x32_bf16 v[0:3], a[0:3], a[32:35], v[0:3]
    ds_read_b128 a[48:51], v104 offset:17408
    v_mfma_f32_16x16x32_bf16 v[4:7], a[0:3], a[36:39], v[4:7]
    ds_read_b128 a[52:55], v104 offset:19456
    v_mfma_f32_16x16x32_bf16 v[8:11], a[0:3], a[40:43], v[8:11]
    ds_read_b128 a[56:59], v104 offset:21504
    v_mfma_f32_16x16x32_bf16 v[12:15], a[0:3], a[44:47], v[12:15]
    ds_read_b128 a[60:63], v104 offset:23552
    v_mfma_f32_16x16x32_bf16 v[16:19], a[4:7], a[32:35], v[16:19]
    ds_read_b64_tr_b16 a[16:17], v96 offset:24576
    v_mfma_f32_16x16x32_bf16 v[20:23], a[4:7], a[36:39], v[20:23]
    ds_read_b64_tr_b16 a[18:19], v96 offset:28672
    v_mfma_f32_16x16x32_bf16 v[24:27], a[4:7], a[40:43], v[24:27]
    ds_read_b64_tr_b16 a[20:21], v97 offset:24576
    v_mfma_f32_16x16x32_bf16 v[28:31], a[4:7], a[44:47], v[28:31]
    ds_read_b64_tr_b16 a[22:23], v97 offset:28672
    v_mfma_f32_16x16x32_bf16 v[32:35], a[8:11], a[32:35], v[32:35]
    ds_read_b64_tr_b16 a[24:25], v98 offset:24576
    v_mfma_f32_16x16x32_bf16 v[36:39], a[8:11], a[36:39], v[36:39]
    ds_read_b64_tr_b16 a[26:27], v98 offset:28672
    v_mfma_f32_16x16x32_bf16 v[40:43], a[8:11], a[40:43], v[40:43]
    ds_read_b64_tr_b16 a[28:29], v99 offset:24576
    v_mfma_f32_16x16x32_bf16 v[44:47], a[8:11], a[44:47], v[44:47]
    ds_read_b64_tr_b16 a[30:31], v99 offset:28672
    v_mfma_f32_16x16x32_bf16 v[48:51], a[12:15], a[32:35], v[48:51]
    v_mfma_f32_16x16x32_bf16 v[52:55], a[12:15], a[36:39], v[52:55]
    v_mfma_f32_16x16x32_bf16 v[56:59], a[12:15], a[40:43], v[56:59]
    v_mfma_f32_16x16x32_bf16 v[60:63], a[12:15], a[44:47], v[60:63]
    s_waitcnt lgkmcnt(0)
    s_barrier
    v_mfma_f32_16x16x32_bf16 v[0:3], a[16:19], a[48:51], v[0:3]
    ds_read_b128 a[32:35], v104 offset:32768
    v_mfma_f32_16x16x32_bf16 v[4:7], a[16:19], a[52:55], v[4:7]
    ds_read_b128 a[36:39], v104 offset:34816
    v_mfma_f32_16x16x32_bf16 v[8:11], a[16:19], a[56:59], v[8:11]
    ds_read_b128 a[40:43], v104 offset:36864
    v_mfma_f32_16x16x32_bf16 v[12:15], a[16:19], a[60:63], v[12:15]
    ds_read_b128 a[44:47], v104 offset:38912
    v_mfma_f32_16x16x32_bf16 v[16:19], a[20:23], a[48:51], v[16:19]
    ds_read_b64_tr_b16 a[0:1], v96 offset:32768
    v_mfma_f32_16x16x32_bf16 v[20:23], a[20:23], a[52:55], v[20:23]
    ds_read_b64_tr_b16 a[2:3], v96 offset:36864
    v_mfma_f32_16x16x32_bf16 v[24:27], a[20:23], a[56:59], v[24:27]
    ds_read_b64_tr_b16 a[4:5], v97 offset:32768
    v_mfma_f32_16x16x32_bf16 v[28:31], a[20:23], a[60:63], v[28:31]
    ds_read_b64_tr_b16 a[6:7], v97 offset:36864
    v_mfma_f32_16x16x32_bf16 v[32:35], a[24:27], a[48:51], v[32:35]
    ds_read_b64_tr_b16 a[8:9], v98 offset:32768
    v_mfma_f32_16x16x32_bf16 v[36:39], a[24:27], a[52:55], v[36:39]
    ds_read_b64_tr_b16 a[10:11], v98 offset:36864
    v_mfma_f32_16x16x32_bf16 v[40:43], a[24:27], a[56:59], v[40:43]
    ds_read_b64_tr_b16 a[12:13], v99 offset:32768
    v_mfma_f32_16x16x32_bf16 v[44:47], a[24:27], a[60:63], v[44:47]
    ds_read_b64_tr_b16 a[14:15], v99 offset:36864
    v_mfma_f32_16x16x32_bf16 v[48:51], a[28:31], a[48:51], v[48:51]
    v_mfma_f32_16x16x32_bf16 v[52:55], a[28:31], a[52:55], v[52:55]
    v_mfma_f32_16x16x32_bf16 v[56:59], a[28:31], a[56:59], v[56:59]
    v_mfma_f32_16x16x32_bf16 v[60:63], a[28:31], a[60:63], v[60:63]
    s_waitcnt lgkmcnt(0)
    v_mfma_f32_16x16x32_bf16 v[0:3], a[0:3], a[32:35], v[0:3]
    ds_read_b128 a[48:51], v104 offset:33792
    v_mfma_f32_16x16x32_bf16 v[4:7], a[0:3], a[36:39], v[4:7]
    ds_read_b128 a[52:55], v104 offset:35840
    v_mfma_f32_16x16x32_bf16 v[8:11], a[0:3], a[40:43], v[8:11]
    ds_read_b128 a[56:59], v104 offset:37888
    v_mfma_f32_16x16x32_bf16 v[12:15], a[0:3], a[44:47], v[12:15]
    ds_read_b128 a[60:63], v104 offset:39936
    v_mfma_f32_16x16x32_bf16 v[16:19], a[4:7], a[32:35], v[16:19]
    ds_read_b64_tr_b16 a[16:17], v96 offset:40960
    v_mfma_f32_16x16x32_bf16 v[20:23], a[4:7], a[36:39], v[20:23]
    ds_read_b64_tr_b16 a[18:19], v96 offset:45056
    v_mfma_f32_16x16x32_bf16 v[24:27], a[4:7], a[40:43], v[24:27]
    ds_read_b64_tr_b16 a[20:21], v97 offset:40960
    v_mfma_f32_16x16x32_bf16 v[28:31], a[4:7], a[44:47], v[28:31]
    ds_read_b64_tr_b16 a[22:23], v97 offset:45056
    v_mfma_f32_16x16x32_bf16 v[32:35], a[8:11], a[32:35], v[32:35]
    ds_read_b64_tr_b16 a[24:25], v98 offset:40960
    v_mfma_f32_16x16x32_bf16 v[36:39], a[8:11], a[36:39], v[36:39]
    ds_read_b64_tr_b16 a[26:27], v98 offset:45056
    v_mfma_f32_16x16x32_bf16 v[40:43], a[8:11], a[40:43], v[40:43]
    ds_read_b64_tr_b16 a[28:29], v99 offset:40960
    v_mfma_f32_16x16x32_bf16 v[44:47], a[8:11], a[44:47], v[44:47]
    ds_read_b64_tr_b16 a[30:31], v99 offset:45056
    v_mfma_f32_16x16x32_bf16 v[48:51], a[12:15], a[32:35], v[48:51]
    v_mfma_f32_16x16x32_bf16 v[52:55], a[12:15], a[36:39], v[52:55]
    v_mfma_f32_16x16x32_bf16 v[56:59], a[12:15], a[40:43], v[56:59]
    v_mfma_f32_16x16x32_bf16 v[60:63], a[12:15], a[44:47], v[60:63]
    s_waitcnt lgkmcnt(0)
    s_barrier
    v_mfma_f32_16x16x32_bf16 v[0:3], a[16:19], a[48:51], v[0:3]
    ds_read_b128 a[32:35], v104 offset:49152
    v_mfma_f32_16x16x32_bf16 v[4:7], a[16:19], a[52:55], v[4:7]
    ds_read_b128 a[36:39], v104 offset:51200
    v_mfma_f32_16x16x32_bf16 v[8:11], a[16:19], a[56:59], v[8:11]
    ds_read_b128 a[40:43], v104 offset:53248
    v_mfma_f32_16x16x32_bf16 v[12:15], a[16:19], a[60:63], v[12:15]
    ds_read_b128 a[44:47], v104 offset:55296
    v_mfma_f32_16x16x32_bf16 v[16:19], a[20:23], a[48:51], v[16:19]
    ds_read_b64_tr_b16 a[0:1], v96 offset:49152
    v_mfma_f32_16x16x32_bf16 v[20:23], a[20:23], a[52:55], v[20:23]
    ds_read_b64_tr_b16 a[2:3], v96 offset:53248
    v_mfma_f32_16x16x32_bf16 v[24:27], a[20:23], a[56:59], v[24:27]
    ds_read_b64_tr_b16 a[4:5], v97 offset:49152
    v_mfma_f32_16x16x32_bf16 v[28:31], a[20:23], a[60:63], v[28:31]
    ds_read_b64_tr_b16 a[6:7], v97 offset:53248
    v_mfma_f32_16x16x32_bf16 v[32:35], a[24:27], a[48:51], v[32:35]
    ds_read_b64_tr_b16 a[8:9], v98 offset:49152
    v_mfma_f32_16x16x32_bf16 v[36:39], a[24:27], a[52:55], v[36:39]
    ds_read_b64_tr_b16 a[10:11], v98 offset:53248
    v_mfma_f32_16x16x32_bf16 v[40:43], a[24:27], a[56:59], v[40:43]
    ds_read_b64_tr_b16 a[12:13], v99 offset:49152
    v_mfma_f32_16x16x32_bf16 v[44:47], a[24:27], a[60:63], v[44:47]
    ds_read_b64_tr_b16 a[14:15], v99 offset:53248
    v_mfma_f32_16x16x32_bf16 v[48:51], a[28:31], a[48:51], v[48:51]
    v_mfma_f32_16x16x32_bf16 v[52:55], a[28:31], a[52:55], v[52:55]
    v_mfma_f32_16x16x32_bf16 v[56:59], a[28:31], a[56:59], v[56:59]
    v_mfma_f32_16x16x32_bf16 v[60:63], a[28:31], a[60:63], v[60:63]
    s_waitcnt lgkmcnt(0)
    v_mfma_f32_16x16x32_bf16 v[0:3], a[0:3], a[32:35], v[0:3]
    ds_read_b128 a[48:51], v104 offset:50176
    v_mfma_f32_16x16x32_bf16 v[4:7], a[0:3], a[36:39], v[4:7]
    ds_read_b128 a[52:55], v104 offset:52224
    v_mfma_f32_16x16x32_bf16 v[8:11], a[0:3], a[40:43], v[8:11]
    ds_read_b128 a[56:59], v104 offset:54272
    v_mfma_f32_16x16x32_bf16 v[12:15], a[0:3], a[44:47], v[12:15]
    ds_read_b128 a[60:63], v104 offset:56320
    v_mfma_f32_16x16x32_bf16 v[16:19], a[4:7], a[32:35], v[16:19]
    ds_read_b64_tr_b16 a[16:17], v96 offset:57344
    v_mfma_f32_16x16x32_bf16 v[20:23], a[4:7], a[36:39], v[20:23]
    ds_read_b64_tr_b16 a[18:19], v96 offset:61440
    v_mfma_f32_16x16x32_bf16 v[24:27], a[4:7], a[40:43], v[24:27]
    ds_read_b64_tr_b16 a[20:21], v97 offset:57344
    v_mfma_f32_16x16x32_bf16 v[28:31], a[4:7], a[44:47], v[28:31]
    ds_read_b64_tr_b16 a[22:23], v97 offset:61440
    v_mfma_f32_16x16x32_bf16 v[32:35], a[8:11], a[32:35], v[32:35]
    ds_read_b64_tr_b16 a[24:25], v98 offset:57344
    v_mfma_f32_16x16x32_bf16 v[36:39], a[8:11], a[36:39], v[36:39]
    ds_read_b64_tr_b16 a[26:27], v98 offset:61440
    v_mfma_f32_16x16x32_bf16 v[40:43], a[8:11], a[40:43], v[40:43]
    ds_read_b64_tr_b16 a[28:29], v99 offset:57344
    v_mfma_f32_16x16x32_bf16 v[44:47], a[8:11], a[44:47], v[44:47]
    ds_read_b64_tr_b16 a[30:31], v99 offset:61440
    v_mfma_f32_16x16x32_bf16 v[48:51], a[12:15], a[32:35], v[48:51]
    v_mfma_f32_16x16x32_bf16 v[52:55], a[12:15], a[36:39], v[52:55]
    v_mfma_f32_16x16x32_bf16 v[56:59], a[12:15], a[40:43], v[56:59]
    v_mfma_f32_16x16x32_bf16 v[60:63], a[12:15], a[44:47], v[60:63]
    s_waitcnt lgkmcnt(0)
    v_mfma_f32_16x16x32_bf16 v[0:3], a[16:19], a[48:51], v[0:3]
    v_mfma_f32_16x16x32_bf16 v[4:7], a[16:19], a[52:55], v[4:7]
    v_mfma_f32_16x16x32_bf16 v[8:11], a[16:19], a[56:59], v[8:11]
    v_mfma_f32_16x16x32_bf16 v[12:15], a[16:19], a[60:63], v[12:15]
    v_mfma_f32_16x16x32_bf16 v[16:19], a[20:23], a[48:51], v[16:19]
    v_mfma_f32_16x16x32_bf16 v[20:23], a[20:23], a[52:55], v[20:23]
    v_mfma_f32_16x16x32_bf16 v[24:27], a[20:23], a[56:59], v[24:27]
    v_mfma_f32_16x16x32_bf16 v[28:31], a[20:23], a[60:63], v[28:31]
    v_mfma_f32_16x16x32_bf16 v[32:35], a[24:27], a[48:51], v[32:35]
    v_mfma_f32_16x16x32_bf16 v[36:39], a[24:27], a[52:55], v[36:39]
    v_mfma_f32_16x16x32_bf16 v[40:43], a[24:27], a[56:59], v[40:43]
    v_mfma_f32_16x16x32_bf16 v[44:47], a[24:27], a[60:63], v[44:47]
    v_mfma_f32_16x16x32_bf16 v[48:51], a[28:31], a[48:51], v[48:51]
    v_mfma_f32_16x16x32_bf16 v[52:55], a[28:31], a[52:55], v[52:55]
    v_mfma_f32_16x16x32_bf16 v[56:59], a[28:31], a[56:59], v[56:59]
    v_mfma_f32_16x16x32_bf16 v[60:63], a[28:31], a[60:63], v[60:63]
    s_lshl_b32 s40, s62, 14
    s_lshl_b32 s41, s38, 12
    s_add_u32 s40, s40, s41
    s_nop 4
    s_cmp_eq_u32 s62, 0
    s_cbranch_scc1 L_skipst0
    s_add_u32 s42, s40, 0
    v_cvt_pk_bf16_f32 v0, v0, v1
    v_cvt_pk_bf16_f32 v1, v2, v3
    v_cvt_pk_bf16_f32 v2, v4, v5
    v_cvt_pk_bf16_f32 v3, v6, v7
    buffer_store_dwordx4 v[0:3], v107, s[72:75], s42 offen offset:0 sc0 sc1
    v_cvt_pk_bf16_f32 v8, v8, v9
    v_cvt_pk_bf16_f32 v9, v10, v11
    v_cvt_pk_bf16_f32 v10, v12, v13
    v_cvt_pk_bf16_f32 v11, v14, v15
    buffer_store_dwordx4 v[8:11], v107, s[72:75], s42 offen offset:1024 sc0 sc1
L_skipst0:
    s_cmp_eq_u32 s62, 1
    s_cbranch_scc1 L_skipst1
    s_add_u32 s42, s40, 65536
    v_cvt_pk_bf16_f32 v16, v16, v17
    v_cvt_pk_bf16_f32 v17, v18, v19
    v_cvt_pk_bf16_f32 v18, v20, v21
    v_cvt_pk_bf16_f32 v19, v22, v23
    buffer_store_dwordx4 v[16:19], v107, s[72:75], s42 offen offset:0 sc0 sc1
    v_cvt_pk_bf16_f32 v24, v24, v25
    v_cvt_pk_bf16_f32 v25, v26, v27
    v_cvt_pk_bf16_f32 v26, v28, v29
    v_cvt_pk_bf16_f32 v27, v30, v31
    buffer_store_dwordx4 v[24:27], v107, s[72:75], s42 offen offset:1024 sc0 sc1
L_skipst1:
    s_cmp_eq_u32 s62, 2
    s_cbranch_scc1 L_skipst2
    s_add_u32 s42, s40, 131072
    v_cvt_pk_bf16_f32 v32, v32, v33
    v_cvt_pk_bf16_f32 v33, v34, v35
    v_cvt_pk_bf16_f32 v34, v36, v37
    v_cvt_pk_bf16_f32 v35, v38, v39
    buffer_store_dwordx4 v[32:35], v107, s[72:75], s42 offen offset:0 sc0 sc1
    v_cvt_pk_bf16_f32 v40, v40, v41
    v_cvt_pk_bf16_f32 v41, v42, v43
    v_cvt_pk_bf16_f32 v42, v44, v45
    v_cvt_pk_bf16_f32 v43, v46, v47
    buffer_store_dwordx4 v[40:43], v107, s[72:75], s42 offen offset:1024 sc0 sc1
L_skipst2:
    s_cmp_eq_u32 s62, 3
    s_cbranch_scc1 L_skipst3
    s_add_u32 s42, s40, 196608
    v_cvt_pk_bf16_f32 v48, v48, v49
    v_cvt_pk_bf16_f32 v49, v50, v51
    v_cvt_pk_bf16_f32 v50, v52, v53
    v_cvt_pk_bf16_f32 v51, v54, v55
    buffer_store_dwordx4 v[48:51], v107, s[72:75], s42 offen offset:0 sc0 sc1
    v_cvt_pk_bf16_f32 v56, v56, v57
    v_cvt_pk_bf16_f32 v57, v58, v59
    v_cvt_pk_bf16_f32 v58, v60, v61
    v_cvt_pk_bf16_f32 v59, v62, v63
    buffer_store_dwordx4 v[56:59], v107, s[72:75], s42 offen offset:1024 sc0 sc1
L_skipst3:
    s_cmp_lg_u32 s62, 0
    s_cbranch_scc1 L_skipmv0
    v_mov_b32 v64, v0
    v_mov_b32 v65, v1
    v_mov_b32 v66, v2
    v_mov_b32 v67, v3
    v_mov_b32 v68, v4
    v_mov_b32 v69, v5
    v_mov_b32 v70, v6
    v_mov_b32 v71, v7
    v_mov_b32 v72, v8
    v_mov_b32 v73, v9
    v_mov_b32 v74, v10
    v_mov_b32 v75, v11
    v_mov_b32 v76, v12
    v_mov_b32 v77, v13
    v_mov_b32 v78, v14
    v_mov_b32 v79, v15
L_skipmv0:
    s_cmp_lg_u32 s62, 1
    s_cbranch_scc1 L_skipmv1
    v_mov_b32 v64, v16
    v_mov_b32 v65, v17
    v_mov_b32 v66, v18
    v_mov_b32 v67, v19
    v_mov_b32 v68, v20
    v_mov_b32 v69, v21
    v_mov_b32 v70, v22
    v_mov_b32 v71, v23
    v_mov_b32 v72, v24
    v_mov_b32 v73, v25
    v_mov_b32 v74, v26
    v_mov_b32 v75, v27
    v_mov_b32 v76, v28
    v_mov_b32 v77, v29
    v_mov_b32 v78, v30
    v_mov_b32 v79, v31
L_skipmv1:
    s_cmp_lg_u32 s62, 2
    s_cbranch_scc1 L_skipmv2
    v_mov_b32 v64, v32
    v_mov_b32 v65, v33
    v_mov_b32 v66, v34
    v_mov_b32 v67, v35
    v_mov_b32 v68, v36
    v_mov_b32 v69, v37
    v_mov_b32 v70, v38
    v_mov_b32 v71, v39
    v_mov_b32 v72, v40
    v_mov_b32 v73, v41
    v_mov_b32 v74, v42
    v_mov_b32 v75, v43
    v_mov_b32 v76, v44
    v_mov_b32 v77, v45
    v_mov_b32 v78, v46
    v_mov_b32 v79, v47
L_skipmv2:
    s_cmp_lg_u32 s62, 3
    s_cbranch_scc1 L_skipmv3
    v_mov_b32 v64, v48
    v_mov_b32 v65, v49
    v_mov_b32 v66, v50
    v_mov_b32 v67, v51
    v_mov_b32 v68, v52
    v_mov_b32 v69, v53
    v_mov_b32 v70, v54
    v_mov_b32 v71, v55
    v_mov_b32 v72, v56
    v_mov_b32 v73, v57
    v_mov_b32 v74, v58
    v_mov_b32 v75, v59
    v_mov_b32 v76, v60
    v_mov_b32 v77, v61
    v_mov_b32 v78, v62
    v_mov_b32 v79, v63
L_skipmv3:
    s_lshl_b32 s43, s63, 2
    s_add_u32 s43, s43, s38
    s_lshl_b32 s43, s43, 7
    s_add_u32 s43, s43, 65536
    s_lshl_b32 s46, s62, 3
    v_mov_b32 v114, s46
    v_lshlrev_b32 v112, 3, v111
    s_waitcnt vmcnt(0)
    s_mov_b64 exec, 1
    buffer_store_dwordx2 v[116:117], v114, s[76:79], s43 offen sc0 sc1
    s_mov_b64 exec, 15
    s_mov_b32 s45, 0
L_poll2:
    buffer_load_dwordx2 v[80:81], v112, s[76:79], s43 offen sc0 sc1
    s_add_u32 s45, s45, 1
    s_waitcnt vmcnt(0)
    v_cmp_eq_u64 vcc, v[80:81], v[116:117]
    s_cmp_ge_u32 s45, 0x100000
    s_cbranch_scc1 L_poll2_d
    s_cmp_eq_u64 vcc, 15
    s_cbranch_scc0 L_poll2
L_poll2_d:
    s_mov_b64 exec, -1
    s_lshl_b32 s40, s62, 16
    s_add_u32 s40, s40, s41
    s_add_u32 s42, s62, 1
    s_and_b32 s42, s42, 3
    s_lshl_b32 s42, s42, 14
    s_add_u32 s42, s42, s40
    buffer_load_dwordx4 v[0:3], v107, s[72:75], s42 offen offset:0 sc0 sc1
    buffer_load_dwordx4 v[4:7], v107, s[72:75], s42 offen offset:1024 sc0 sc1
    s_add_u32 s42, s62, 2
    s_and_b32 s42, s42, 3
    s_lshl_b32 s42, s42, 14
    s_add_u32 s42, s42, s40
    buffer_load_dwordx4 v[16:19], v107, s[72:75], s42 offen offset:0 sc0 sc1
    buffer_load_dwordx4 v[20:23], v107, s[72:75], s42 offen offset:1024 sc0 sc1
    s_add_u32 s42, s62, 3
    s_and_b32 s42, s42, 3
    s_lshl_b32 s42, s42, 14
    s_add_u32 s42, s42, s40
    buffer_load_dwordx4 v[32:35], v107, s[72:75], s42 offen offset:0 sc0 sc1
    buffer_load_dwordx4 v[36:39], v107, s[72:75], s42 offen offset:1024 sc0 sc1
    v_mul_u32_u24 v112, 2560, v108
    v_lshlrev_b32 v113, 3, v109
    v_add_u32 v112, v112, v113
    s_and_b32 s40, s38, 1
    s_mul_i32 s40, s40, 163840
    s_lshr_b32 s42, s38, 1
    s_lshl_b32 s42, s42, 7
    s_add_u32 s40, s40, s42
    s_lshl_b32 s42, s62, 5
    s_add_u32 s40, s40, s42
    s_waitcnt vmcnt(0)
    v_lshlrev_b32 v113, 16, v0
    v_and_b32 v114, 0xffff0000, v0
    v_add_f32 v64, v64, v113
    v_add_f32 v65, v65, v114
    v_lshlrev_b32 v113, 16, v1
    v_and_b32 v114, 0xffff0000, v1
    v_add_f32 v66, v66, v113
    v_add_f32 v67, v67, v114
    v_lshlrev_b32 v113, 16, v16
    v_and_b32 v114, 0xffff0000, v16
    v_add_f32 v64, v64, v113
    v_add_f32 v65, v65, v114
    v_lshlrev_b32 v113, 16, v17
    v_and_b32 v114, 0xffff0000, v17
    v_add_f32 v66, v66, v113
    v_add_f32 v67, v67, v114
    v_lshlrev_b32 v113, 16, v32
    v_and_b32 v114, 0xffff0000, v32
    v_add_f32 v64, v64, v113
    v_add_f32 v65, v65, v114
    v_lshlrev_b32 v113, 16, v33
    v_and_b32 v114, 0xffff0000, v33
    v_add_f32 v66, v66, v113
    v_add_f32 v67, v67, v114
    v_cvt_pk_bf16_f32 v64, v64, v65
    v_cvt_pk_bf16_f32 v65, v66, v67
    s_add_u32 s42, s40, 0
    buffer_store_dwordx2 v[64:65], v112, s[80:83], s42 offen sc1
    v_lshlrev_b32 v113, 16, v2
    v_and_b32 v114, 0xffff0000, v2
    v_add_f32 v68, v68, v113
    v_add_f32 v69, v69, v114
    v_lshlrev_b32 v113, 16, v3
    v_and_b32 v114, 0xffff0000, v3
    v_add_f32 v70, v70, v113
    v_add_f32 v71, v71, v114
    v_lshlrev_b32 v113, 16, v18
    v_and_b32 v114, 0xffff0000, v18
    v_add_f32 v68, v68, v113
    v_add_f32 v69, v69, v114
    v_lshlrev_b32 v113, 16, v19
    v_and_b32 v114, 0xffff0000, v19
    v_add_f32 v70, v70, v113
    v_add_f32 v71, v71, v114
    v_lshlrev_b32 v113, 16, v34
    v_and_b32 v114, 0xffff0000, v34
    v_add_f32 v68, v68, v113
    v_add_f32 v69, v69, v114
    v_lshlrev_b32 v113, 16, v35
    v_and_b32 v114, 0xffff0000, v35
    v_add_f32 v70, v70, v113
    v_add_f32 v71, v71, v114
    v_cvt_pk_bf16_f32 v68, v68, v69
    v_cvt_pk_bf16_f32 v69, v70, v71
    s_add_u32 s42, s40, 40960
    buffer_store_dwordx2 v[68:69], v112, s[80:83], s42 offen sc1
    v_lshlrev_b32 v113, 16, v4
    v_and_b32 v114, 0xffff0000, v4
    v_add_f32 v72, v72, v113
    v_add_f32 v73, v73, v114
    v_lshlrev_b32 v113, 16, v5
    v_and_b32 v114, 0xffff0000, v5
    v_add_f32 v74, v74, v113
    v_add_f32 v75, v75, v114
    v_lshlrev_b32 v113, 16, v20
    v_and_b32 v114, 0xffff0000, v20
    v_add_f32 v72, v72, v113
    v_add_f32 v73, v73, v114
    v_lshlrev_b32 v113, 16, v21
    v_and_b32 v114, 0xffff0000, v21
    v_add_f32 v74, v74, v113
    v_add_f32 v75, v75, v114
    v_lshlrev_b32 v113, 16, v36
    v_and_b32 v114, 0xffff0000, v36
    v_add_f32 v72, v72, v113
    v_add_f32 v73, v73, v114
    v_lshlrev_b32 v113, 16, v37
    v_and_b32 v114, 0xffff0000, v37
    v_add_f32 v74, v74, v113
    v_add_f32 v75, v75, v114
    v_cvt_pk_bf16_f32 v72, v72, v73
    v_cvt_pk_bf16_f32 v73, v74, v75
    s_add_u32 s42, s40, 81920
    buffer_store_dwordx2 v[72:73], v112, s[80:83], s42 offen sc1
    v_lshlrev_b32 v113, 16, v6
    v_and_b32 v114, 0xffff0000, v6
    v_add_f32 v76, v76, v113
    v_add_f32 v77, v77, v114
    v_lshlrev_b32 v113, 16, v7
    v_and_b32 v114, 0xffff0000, v7
    v_add_f32 v78, v78, v113
    v_add_f32 v79, v79, v114
    v_lshlrev_b32 v113, 16, v22
    v_and_b32 v114, 0xffff0000, v22
    v_add_f32 v76, v76, v113
    v_add_f32 v77, v77, v114
    v_lshlrev_b32 v113, 16, v23
    v_and_b32 v114, 0xffff0000, v23
    v_add_f32 v78, v78, v113
    v_add_f32 v79, v79, v114
    v_lshlrev_b32 v113, 16, v38
    v_and_b32 v114, 0xffff0000, v38
    v_add_f32 v76, v76, v113
    v_add_f32 v77, v77, v114
    v_lshlrev_b32 v113, 16, v39
    v_and_b32 v114, 0xffff0000, v39
    v_add_f32 v78, v78, v113
    v_add_f32 v79, v79, v114
    v_cvt_pk_bf16_f32 v76, v76, v77
    v_cvt_pk_bf16_f32 v77, v78, v79
    s_add_u32 s42, s40, 122880
    buffer_store_dwordx2 v[76:77], v112, s[80:83], s42 offen sc1
L_fin:
L_done:
    s_endpgm
L_end:

.section .rodata,"a"
.p2align 6
.amdhsa_kernel concat_heads__mha_block_cached__gqa_block_cached__near_ridge_kernel
  .amdhsa_next_free_vgpr 224
  .amdhsa_next_free_sgpr 100
  .amdhsa_accum_offset 136
  .amdhsa_group_segment_fixed_size 0
  .amdhsa_kernarg_size 104
  .amdhsa_user_sgpr_count 2
  .amdhsa_user_sgpr_kernarg_segment_ptr 1
  .amdhsa_system_sgpr_workgroup_id_x 1
.end_amdhsa_kernel
```
